```python
import torch

def _softmax(x, axis=-1):
    return torch.softmax(x, dim=axis)
def _gelu(x):
    return torch.nn.functional.gelu(x, approximate="tanh")
def _silu(x):
    return torch.nn.functional.silu(x)
def _sigmoid(x):
    return torch.sigmoid(x)
def _layernorm(x, axis=-1, eps=1e-5):
    m = x.mean(dim=axis, keepdim=True)
    v = x.var(dim=axis, keepdim=True, unbiased=False)
    return (x - m) / torch.sqrt(v + eps)
def _scatter_add(tgt, idx, src, axis=0):
    return tgt.clone().index_add_(axis, idx, src)
def _segment_sum(src, seg, n):
    out = torch.zeros((n,) + src.shape[1:], dtype=src.dtype)
    return out.index_add_(0, seg, src)
def _pad(x, pw):
    flat = tuple(v for pair in reversed(pw) for v in pair)
    return torch.nn.functional.pad(x, flat)

kernel_name = 'standalone__gqa_softmax__near_ridge'

def setup_inputs():

    _w = (lambda a: (lambda t: t.to(torch.bfloat16) if t.is_floating_point() else t)(torch.as_tensor(a)))
    B, Hq, Hkv, Sq, Sk, D = 8, 32, 32, 192, 1024, 128
    return {
        "q": _w((lambda *s: torch.randn(*s, dtype=torch.bfloat16) * 0.8)(B, Hq, Sq, D)),
        "k": _w((lambda *s: torch.randn(*s, dtype=torch.bfloat16) * 0.8)(B, Hkv, Sk, D)),
        "v": _w((lambda *s: torch.randn(*s, dtype=torch.bfloat16) * 0.05)(B, Hkv, Sk, D)),
    }

def reference(q, k, v):
    B, Hq, Sq, D = q.shape
    Hkv = k.shape[1]
    rep = Hq // Hkv
    k = (lambda x, n, axis: torch.repeat_interleave(x, n, dim=axis))(k, rep, axis=1)
    v = (lambda x, n, axis: torch.repeat_interleave(x, n, dim=axis))(v, rep, axis=1)
    scale = D ** -0.5
    scores = torch.einsum("bhqd,bhkd->bhqk", q, k) * scale
    p = _softmax(scores, axis=-1)
    return torch.einsum("bhqk,bhkd->bhqd", p, v)
```

```asm
; @launch grid=(256,1,1) block=(256,1,1) lds=163840
.amdgcn_target "amdgcn-amd-amdhsa--gfx950"
.text
.globl standalone__gqa_softmax__near_ridge_kernel
.p2align 8
.type standalone__gqa_softmax__near_ridge_kernel,@function
standalone__gqa_softmax__near_ridge_kernel:
    s_cmp_ge_u32 s2, 256
    s_cbranch_scc1 L_end
    s_load_dwordx8 s[4:11], s[0:1], 0
    v_lshrrev_b32 v32, 6, v0
    v_and_b32 v1, 63, v0
    v_readfirstlane_b32 s28, v32
    v_lshrrev_b32 v32, 4, v1
    v_and_b32 v33, 15, v1
    v_xor_b32 v34, v33, v32
    v_lshlrev_b32 v34, 4, v34
    v_lshl_add_u32 v2, v32, 8, v34
    v_xor_b32 v3, 64, v2
    v_xor_b32 v4, 128, v2
    v_xor_b32 v5, 192, v2
    v_lshlrev_b32 v34, 1, v32
    v_xor_b32 v34, v33, v34
    v_lshlrev_b32 v34, 4, v34
    v_lshl_add_u32 v6, v32, 8, v34
    v_xor_b32 v7, 0x80, v6
    s_mul_i32 s40, s2, 49152
    s_lshl_b32 s41, s2, 18
    s_mul_i32 s47, s28, 12288
    s_add_u32 s48, s47, 4096
    s_add_u32 s49, s47, 8192
    s_mov_b32 s32, 0x3e0293ee
    s_mov_b32 s33, 0xbe0293ee
    s_lshl_b32 s38, s28, 12
    s_mov_b32 s39, s38
    s_mov_b32 s36, s38
    s_mov_b32 s37, s38
    s_add_u32 s30, s47, 114688
    s_add_u32 s44, s47, 32768
    s_add_u32 s31, s47, 106496
    s_cmp_lt_u32 s28, 2
    s_cselect_b32 s44, s44, s31
    s_lshr_b32 s34, s2, 3
    s_and_b32 s34, s34, 7
    s_lshl_b32 s34, s34, 2
    s_lshr_b32 s34, 0x66660000, s34
    s_and_b32 s34, s34, 7
    s_waitcnt lgkmcnt(0)
    s_add_u32 s12, s4, s40
    s_addc_u32 s13, s5, 0
    s_mov_b32 s14, 49152
    s_mov_b32 s15, 0x00020000
    s_add_u32 s16, s6, s41
    s_addc_u32 s17, s7, 0
    s_mov_b32 s18, 262144
    s_mov_b32 s19, 0x00020000
    s_add_u32 s20, s8, s41
    s_addc_u32 s21, s9, 0
    s_mov_b32 s22, 262144
    s_mov_b32 s23, 0x00020000
    s_add_u32 s24, s10, s40
    s_addc_u32 s25, s11, 0
    s_mov_b32 s26, 49152
    s_mov_b32 s27, 0x00020000
    s_cmp_eq_u32 s34, 0
    s_cbranch_scc1 L_safe2
    s_mov_b32 m0, s30
    s_nop 0
    buffer_load_dwordx4 v2, s[12:15], s47 offen nt lds
    buffer_load_dwordx4 v3, s[12:15], s47 offen offset:1024 nt lds
    buffer_load_dwordx4 v4, s[12:15], s47 offen offset:2048 nt lds
    buffer_load_dwordx4 v5, s[12:15], s47 offen offset:3072 nt lds
    s_add_u32 s40, s30, 4096
    s_mov_b32 m0, s40
    s_nop 0
    buffer_load_dwordx4 v2, s[12:15], s48 offen nt lds
    buffer_load_dwordx4 v3, s[12:15], s48 offen offset:1024 nt lds
    buffer_load_dwordx4 v4, s[12:15], s48 offen offset:2048 nt lds
    buffer_load_dwordx4 v5, s[12:15], s48 offen offset:3072 nt lds
    s_add_u32 s40, s30, 8192
    s_mov_b32 m0, s40
    s_nop 0
    buffer_load_dwordx4 v2, s[12:15], s49 offen nt lds
    buffer_load_dwordx4 v3, s[12:15], s49 offen offset:1024 nt lds
    buffer_load_dwordx4 v4, s[12:15], s49 offen offset:2048 nt lds
    buffer_load_dwordx4 v5, s[12:15], s49 offen offset:3072 nt lds
    s_mov_b32 m0, s38
    s_add_u32 s38, s38, 16384
    buffer_load_dwordx4 v2, s[16:19], s36 offen nt lds
    buffer_load_dwordx4 v3, s[16:19], s36 offen offset:1024 nt lds
    buffer_load_dwordx4 v4, s[16:19], s36 offen offset:2048 nt lds
    buffer_load_dwordx4 v5, s[16:19], s36 offen offset:3072 nt lds
    s_add_u32 s36, s36, 16384
    s_and_b32 s38, s38, 0xffff
    s_getpc_b64 s[42:43]
    s_lshl_b32 s41, s28, 10
    v_lshlrev_b32 v35, 4, v1
    v_add_u32 v35, s41, v35
    global_load_dwordx4 v[208:211], v35, s[42:43]
    v_add_u32 v35, 4096, v35
    global_load_dwordx4 v[212:215], v35, s[42:43]
    v_add_u32 v35, 4096, v35
    global_load_dwordx4 v[216:219], v35, s[42:43]
    v_add_u32 v35, 4096, v35
    global_load_dwordx4 v[220:223], v35, s[42:43]
    v_and_b32 v32, 15, v1
    v_lshrrev_b32 v33, 4, v1
    v_xor_b32 v34, v32, v33
    v_lshlrev_b32 v34, 4, v34
    v_lshl_add_u32 v8, v32, 8, v34
    v_lshrrev_b32 v32, 2, v1
    v_and_b32 v33, 7, v32
    v_lshlrev_b32 v33, 5, v33
    v_lshl_add_u32 v33, v32, 8, v33
    v_and_b32 v32, 3, v1
    v_lshl_add_u32 v9, v32, 3, v33
    v_mov_b32 v64, 0
    v_mov_b32 v65, 0
    v_mov_b32 v66, 0
    v_mov_b32 v67, 0
    v_mov_b32 v68, 0
    v_mov_b32 v69, 0
    v_mov_b32 v70, 0
    v_mov_b32 v71, 0
    v_mov_b32 v72, 0
    v_mov_b32 v73, 0
    v_mov_b32 v74, 0
    v_mov_b32 v75, 0
    v_mov_b32 v76, 0
    v_mov_b32 v77, 0
    v_mov_b32 v78, 0
    v_mov_b32 v79, 0
    v_mov_b32 v80, 0
    v_mov_b32 v81, 0
    v_mov_b32 v82, 0
    v_mov_b32 v83, 0
    v_mov_b32 v84, 0
    v_mov_b32 v85, 0
    v_mov_b32 v86, 0
    v_mov_b32 v87, 0
    v_mov_b32 v88, 0
    v_mov_b32 v89, 0
    v_mov_b32 v90, 0
    v_mov_b32 v91, 0
    v_mov_b32 v92, 0
    v_mov_b32 v93, 0
    v_mov_b32 v94, 0
    v_mov_b32 v95, 0
    v_mov_b32 v96, 0
    v_mov_b32 v97, 0
    v_mov_b32 v98, 0
    v_mov_b32 v99, 0
    v_mov_b32 v100, 0
    v_mov_b32 v101, 0
    v_mov_b32 v102, 0
    v_mov_b32 v103, 0
    v_mov_b32 v104, 0
    v_mov_b32 v105, 0
    v_mov_b32 v106, 0
    v_mov_b32 v107, 0
    v_mov_b32 v108, 0
    v_mov_b32 v109, 0
    v_mov_b32 v110, 0
    v_mov_b32 v111, 0
    v_mov_b32 v112, 0
    v_mov_b32 v113, 0
    v_mov_b32 v114, 0
    v_mov_b32 v115, 0
    v_mov_b32 v116, 0
    v_mov_b32 v117, 0
    v_mov_b32 v118, 0
    v_mov_b32 v119, 0
    v_mov_b32 v120, 0
    v_mov_b32 v121, 0
    v_mov_b32 v122, 0
    v_mov_b32 v123, 0
    v_mov_b32 v124, 0
    v_mov_b32 v125, 0
    v_mov_b32 v126, 0
    v_mov_b32 v127, 0
    v_mov_b32 v128, 0
    v_mov_b32 v129, 0
    v_mov_b32 v130, 0
    v_mov_b32 v131, 0
    v_mov_b32 v132, 0
    v_mov_b32 v133, 0
    v_mov_b32 v134, 0
    v_mov_b32 v135, 0
    v_mov_b32 v136, 0
    v_mov_b32 v137, 0
    v_mov_b32 v138, 0
    v_mov_b32 v139, 0
    v_mov_b32 v140, 0
    v_mov_b32 v141, 0
    v_mov_b32 v142, 0
    v_mov_b32 v143, 0
    v_mov_b32 v144, 0
    v_mov_b32 v145, 0
    v_mov_b32 v146, 0
    v_mov_b32 v147, 0
    v_mov_b32 v148, 0
    v_mov_b32 v149, 0
    v_mov_b32 v150, 0
    v_mov_b32 v151, 0
    v_mov_b32 v152, 0
    v_mov_b32 v153, 0
    v_mov_b32 v154, 0
    v_mov_b32 v155, 0
    v_mov_b32 v156, 0
    v_mov_b32 v157, 0
    v_mov_b32 v158, 0
    v_mov_b32 v159, 0
    v_mov_b32 v10, 0
    v_mov_b32 v13, 0
    v_mov_b32 v11, 0
    v_mov_b32 v14, 0
    v_mov_b32 v12, 0
    v_mov_b32 v15, 0
    v_and_b32 v240, 15, v1
    v_bfe_u32 v241, v1, 4, 1
    v_lshrrev_b32 v242, 5, v1
    v_lshl_add_u32 v241, v241, 1, v242
    v_xor_b32 v241, v241, v240
    v_lshlrev_b32 v241, 4, v241
    v_lshl_add_u32 v243, v240, 8, v241
    v_lshlrev_b32 v238, 4, v1
    s_waitcnt vmcnt(8)
    s_mov_b32 m0, s38
    s_add_u32 s38, s38, 16384
    buffer_load_dwordx4 v2, s[16:19], s36 offen nt lds
    buffer_load_dwordx4 v3, s[16:19], s36 offen offset:1024 nt lds
    buffer_load_dwordx4 v4, s[16:19], s36 offen offset:2048 nt lds
    buffer_load_dwordx4 v5, s[16:19], s36 offen offset:3072 nt lds
    s_add_u32 s36, s36, 16384
    s_and_b32 s38, s38, 0xffff
    s_add_u32 m0, s39, 65536
    s_add_u32 s39, s39, 16384
    buffer_load_dwordx4 v6, s[20:23], s37 offen nt lds
    buffer_load_dwordx4 v7, s[20:23], s37 offen offset:1024 nt lds
    buffer_load_dwordx4 v6, s[20:23], s37 offen offset:2048 nt lds
    buffer_load_dwordx4 v7, s[20:23], s37 offen offset:3072 nt lds
    s_add_u32 s37, s37, 16384
    s_and_b32 s39, s39, 0xffff
    v_add_u32 v20, s30, v8
    v_xor_b32 v21, 64, v20
    v_xor_b32 v22, 128, v20
    v_xor_b32 v23, 192, v20
    ds_read_b128 v[160:163], v20
    ds_read_b128 v[164:167], v21
    ds_read_b128 v[168:171], v22
    ds_read_b128 v[172:175], v23
    ds_read_b128 v[176:179], v20 offset:4096
    ds_read_b128 v[180:183], v21 offset:4096
    ds_read_b128 v[184:187], v22 offset:4096
    ds_read_b128 v[188:191], v23 offset:4096
    ds_read_b128 v[192:195], v20 offset:8192
    ds_read_b128 v[196:199], v21 offset:8192
    ds_read_b128 v[200:203], v22 offset:8192
    ds_read_b128 v[204:207], v23 offset:8192
    s_waitcnt lgkmcnt(11)
    v_lshlrev_b32 v36, 16, v160
    v_and_b32 v37, 0xffff0000, v160
    v_mul_f32 v36, s32, v36
    v_mul_f32 v37, s32, v37
    v_cvt_pk_bf16_f32 v160, v36, v37
    v_lshlrev_b32 v38, 16, v161
    v_and_b32 v39, 0xffff0000, v161
    v_mul_f32 v38, s32, v38
    v_mul_f32 v39, s32, v39
    v_cvt_pk_bf16_f32 v161, v38, v39
    v_accvgpr_write_b32 a0, v160
    v_lshlrev_b32 v40, 16, v162
    v_and_b32 v41, 0xffff0000, v162
    v_mul_f32 v40, s32, v40
    v_mul_f32 v41, s32, v41
    v_cvt_pk_bf16_f32 v162, v40, v41
    v_accvgpr_write_b32 a1, v161
    v_lshlrev_b32 v36, 16, v163
    v_and_b32 v37, 0xffff0000, v163
    v_mul_f32 v36, s32, v36
    v_mul_f32 v37, s32, v37
    v_cvt_pk_bf16_f32 v163, v36, v37
    v_accvgpr_write_b32 a2, v162
    v_accvgpr_write_b32 a3, v163
    s_waitcnt lgkmcnt(10)
    v_lshlrev_b32 v36, 16, v164
    v_and_b32 v37, 0xffff0000, v164
    v_mul_f32 v36, s32, v36
    v_mul_f32 v37, s32, v37
    v_cvt_pk_bf16_f32 v164, v36, v37
    v_lshlrev_b32 v38, 16, v165
    v_and_b32 v39, 0xffff0000, v165
    v_mul_f32 v38, s32, v38
    v_mul_f32 v39, s32, v39
    v_cvt_pk_bf16_f32 v165, v38, v39
    v_accvgpr_write_b32 a4, v164
    v_lshlrev_b32 v40, 16, v166
    v_and_b32 v41, 0xffff0000, v166
    v_mul_f32 v40, s32, v40
    v_mul_f32 v41, s32, v41
    v_cvt_pk_bf16_f32 v166, v40, v41
    v_accvgpr_write_b32 a5, v165
    v_lshlrev_b32 v36, 16, v167
    v_and_b32 v37, 0xffff0000, v167
    v_mul_f32 v36, s32, v36
    v_mul_f32 v37, s32, v37
    v_cvt_pk_bf16_f32 v167, v36, v37
    v_accvgpr_write_b32 a6, v166
    v_accvgpr_write_b32 a7, v167
    s_waitcnt lgkmcnt(9)
    v_lshlrev_b32 v36, 16, v168
    v_and_b32 v37, 0xffff0000, v168
    v_mul_f32 v36, s32, v36
    v_mul_f32 v37, s32, v37
    v_cvt_pk_bf16_f32 v168, v36, v37
    v_lshlrev_b32 v38, 16, v169
    v_and_b32 v39, 0xffff0000, v169
    v_mul_f32 v38, s32, v38
    v_mul_f32 v39, s32, v39
    v_cvt_pk_bf16_f32 v169, v38, v39
    v_accvgpr_write_b32 a8, v168
    v_lshlrev_b32 v40, 16, v170
    v_and_b32 v41, 0xffff0000, v170
    v_mul_f32 v40, s32, v40
    v_mul_f32 v41, s32, v41
    v_cvt_pk_bf16_f32 v170, v40, v41
    v_accvgpr_write_b32 a9, v169
    v_lshlrev_b32 v36, 16, v171
    v_and_b32 v37, 0xffff0000, v171
    v_mul_f32 v36, s32, v36
    v_mul_f32 v37, s32, v37
    v_cvt_pk_bf16_f32 v171, v36, v37
    v_accvgpr_write_b32 a10, v170
    v_accvgpr_write_b32 a11, v171
    s_waitcnt lgkmcnt(8)
    v_lshlrev_b32 v36, 16, v172
    v_and_b32 v37, 0xffff0000, v172
    v_mul_f32 v36, s32, v36
    v_mul_f32 v37, s32, v37
    v_cvt_pk_bf16_f32 v172, v36, v37
    v_lshlrev_b32 v38, 16, v173
    v_and_b32 v39, 0xffff0000, v173
    v_mul_f32 v38, s32, v38
    v_mul_f32 v39, s32, v39
    v_cvt_pk_bf16_f32 v173, v38, v39
    v_accvgpr_write_b32 a12, v172
    v_lshlrev_b32 v40, 16, v174
    v_and_b32 v41, 0xffff0000, v174
    v_mul_f32 v40, s32, v40
    v_mul_f32 v41, s32, v41
    v_cvt_pk_bf16_f32 v174, v40, v41
    v_accvgpr_write_b32 a13, v173
    v_lshlrev_b32 v36, 16, v175
    v_and_b32 v37, 0xffff0000, v175
    v_mul_f32 v36, s32, v36
    v_mul_f32 v37, s32, v37
    v_cvt_pk_bf16_f32 v175, v36, v37
    v_accvgpr_write_b32 a14, v174
    v_accvgpr_write_b32 a15, v175
    s_waitcnt lgkmcnt(7)
    v_lshlrev_b32 v36, 16, v176
    v_and_b32 v37, 0xffff0000, v176
    v_mul_f32 v36, s32, v36
    v_mul_f32 v37, s32, v37
    v_cvt_pk_bf16_f32 v176, v36, v37
    v_lshlrev_b32 v38, 16, v177
    v_and_b32 v39, 0xffff0000, v177
    v_mul_f32 v38, s32, v38
    v_mul_f32 v39, s32, v39
    v_cvt_pk_bf16_f32 v177, v38, v39
    v_accvgpr_write_b32 a16, v176
    v_lshlrev_b32 v40, 16, v178
    v_and_b32 v41, 0xffff0000, v178
    v_mul_f32 v40, s32, v40
    v_mul_f32 v41, s32, v41
    v_cvt_pk_bf16_f32 v178, v40, v41
    v_accvgpr_write_b32 a17, v177
    v_lshlrev_b32 v36, 16, v179
    v_and_b32 v37, 0xffff0000, v179
    v_mul_f32 v36, s32, v36
    v_mul_f32 v37, s32, v37
    v_cvt_pk_bf16_f32 v179, v36, v37
    v_accvgpr_write_b32 a18, v178
    v_accvgpr_write_b32 a19, v179
    s_waitcnt lgkmcnt(6)
    v_lshlrev_b32 v36, 16, v180
    v_and_b32 v37, 0xffff0000, v180
    v_mul_f32 v36, s32, v36
    v_mul_f32 v37, s32, v37
    v_cvt_pk_bf16_f32 v180, v36, v37
    v_lshlrev_b32 v38, 16, v181
    v_and_b32 v39, 0xffff0000, v181
    v_mul_f32 v38, s32, v38
    v_mul_f32 v39, s32, v39
    v_cvt_pk_bf16_f32 v181, v38, v39
    v_accvgpr_write_b32 a20, v180
    v_lshlrev_b32 v40, 16, v182
    v_and_b32 v41, 0xffff0000, v182
    v_mul_f32 v40, s32, v40
    v_mul_f32 v41, s32, v41
    v_cvt_pk_bf16_f32 v182, v40, v41
    v_accvgpr_write_b32 a21, v181
    v_lshlrev_b32 v36, 16, v183
    v_and_b32 v37, 0xffff0000, v183
    v_mul_f32 v36, s32, v36
    v_mul_f32 v37, s32, v37
    v_cvt_pk_bf16_f32 v183, v36, v37
    v_accvgpr_write_b32 a22, v182
    v_accvgpr_write_b32 a23, v183
    s_waitcnt lgkmcnt(5)
    v_lshlrev_b32 v36, 16, v184
    v_and_b32 v37, 0xffff0000, v184
    v_mul_f32 v36, s32, v36
    v_mul_f32 v37, s32, v37
    v_cvt_pk_bf16_f32 v184, v36, v37
    v_lshlrev_b32 v38, 16, v185
    v_and_b32 v39, 0xffff0000, v185
    v_mul_f32 v38, s32, v38
    v_mul_f32 v39, s32, v39
    v_cvt_pk_bf16_f32 v185, v38, v39
    v_accvgpr_write_b32 a24, v184
    v_lshlrev_b32 v40, 16, v186
    v_and_b32 v41, 0xffff0000, v186
    v_mul_f32 v40, s32, v40
    v_mul_f32 v41, s32, v41
    v_cvt_pk_bf16_f32 v186, v40, v41
    v_accvgpr_write_b32 a25, v185
    v_lshlrev_b32 v36, 16, v187
    v_and_b32 v37, 0xffff0000, v187
    v_mul_f32 v36, s32, v36
    v_mul_f32 v37, s32, v37
    v_cvt_pk_bf16_f32 v187, v36, v37
    v_accvgpr_write_b32 a26, v186
    v_accvgpr_write_b32 a27, v187
    s_waitcnt lgkmcnt(4)
    v_lshlrev_b32 v36, 16, v188
    v_and_b32 v37, 0xffff0000, v188
    v_mul_f32 v36, s32, v36
    v_mul_f32 v37, s32, v37
    v_cvt_pk_bf16_f32 v188, v36, v37
    v_lshlrev_b32 v38, 16, v189
    v_and_b32 v39, 0xffff0000, v189
    v_mul_f32 v38, s32, v38
    v_mul_f32 v39, s32, v39
    v_cvt_pk_bf16_f32 v189, v38, v39
    v_accvgpr_write_b32 a28, v188
    v_lshlrev_b32 v40, 16, v190
    v_and_b32 v41, 0xffff0000, v190
    v_mul_f32 v40, s32, v40
    v_mul_f32 v41, s32, v41
    v_cvt_pk_bf16_f32 v190, v40, v41
    v_accvgpr_write_b32 a29, v189
    v_lshlrev_b32 v36, 16, v191
    v_and_b32 v37, 0xffff0000, v191
    v_mul_f32 v36, s32, v36
    v_mul_f32 v37, s32, v37
    v_cvt_pk_bf16_f32 v191, v36, v37
    v_accvgpr_write_b32 a30, v190
    v_accvgpr_write_b32 a31, v191
    s_waitcnt lgkmcnt(3)
    v_lshlrev_b32 v36, 16, v192
    v_and_b32 v37, 0xffff0000, v192
    v_mul_f32 v36, s32, v36
    v_mul_f32 v37, s32, v37
    v_cvt_pk_bf16_f32 v192, v36, v37
    v_lshlrev_b32 v38, 16, v193
    v_and_b32 v39, 0xffff0000, v193
    v_mul_f32 v38, s32, v38
    v_mul_f32 v39, s32, v39
    v_cvt_pk_bf16_f32 v193, v38, v39
    v_accvgpr_write_b32 a32, v192
    v_lshlrev_b32 v40, 16, v194
    v_and_b32 v41, 0xffff0000, v194
    v_mul_f32 v40, s32, v40
    v_mul_f32 v41, s32, v41
    v_cvt_pk_bf16_f32 v194, v40, v41
    v_accvgpr_write_b32 a33, v193
    v_lshlrev_b32 v36, 16, v195
    v_and_b32 v37, 0xffff0000, v195
    v_mul_f32 v36, s32, v36
    v_mul_f32 v37, s32, v37
    v_cvt_pk_bf16_f32 v195, v36, v37
    v_accvgpr_write_b32 a34, v194
    v_accvgpr_write_b32 a35, v195
    s_waitcnt lgkmcnt(2)
    v_lshlrev_b32 v36, 16, v196
    v_and_b32 v37, 0xffff0000, v196
    v_mul_f32 v36, s32, v36
    v_mul_f32 v37, s32, v37
    v_cvt_pk_bf16_f32 v196, v36, v37
    v_lshlrev_b32 v38, 16, v197
    v_and_b32 v39, 0xffff0000, v197
    v_mul_f32 v38, s32, v38
    v_mul_f32 v39, s32, v39
    v_cvt_pk_bf16_f32 v197, v38, v39
    v_accvgpr_write_b32 a36, v196
    v_lshlrev_b32 v40, 16, v198
    v_and_b32 v41, 0xffff0000, v198
    v_mul_f32 v40, s32, v40
    v_mul_f32 v41, s32, v41
    v_cvt_pk_bf16_f32 v198, v40, v41
    v_accvgpr_write_b32 a37, v197
    v_lshlrev_b32 v36, 16, v199
    v_and_b32 v37, 0xffff0000, v199
    v_mul_f32 v36, s32, v36
    v_mul_f32 v37, s32, v37
    v_cvt_pk_bf16_f32 v199, v36, v37
    v_accvgpr_write_b32 a38, v198
    v_accvgpr_write_b32 a39, v199
    s_waitcnt lgkmcnt(1)
    v_lshlrev_b32 v36, 16, v200
    v_and_b32 v37, 0xffff0000, v200
    v_mul_f32 v36, s32, v36
    v_mul_f32 v37, s32, v37
    v_cvt_pk_bf16_f32 v200, v36, v37
    v_lshlrev_b32 v38, 16, v201
    v_and_b32 v39, 0xffff0000, v201
    v_mul_f32 v38, s32, v38
    v_mul_f32 v39, s32, v39
    v_cvt_pk_bf16_f32 v201, v38, v39
    v_accvgpr_write_b32 a40, v200
    v_lshlrev_b32 v40, 16, v202
    v_and_b32 v41, 0xffff0000, v202
    v_mul_f32 v40, s32, v40
    v_mul_f32 v41, s32, v41
    v_cvt_pk_bf16_f32 v202, v40, v41
    v_accvgpr_write_b32 a41, v201
    v_lshlrev_b32 v36, 16, v203
    v_and_b32 v37, 0xffff0000, v203
    v_mul_f32 v36, s32, v36
    v_mul_f32 v37, s32, v37
    v_cvt_pk_bf16_f32 v203, v36, v37
    v_accvgpr_write_b32 a42, v202
    v_accvgpr_write_b32 a43, v203
    s_waitcnt lgkmcnt(0)
    v_lshlrev_b32 v36, 16, v204
    v_and_b32 v37, 0xffff0000, v204
    v_mul_f32 v36, s32, v36
    v_mul_f32 v37, s32, v37
    v_cvt_pk_bf16_f32 v204, v36, v37
    v_lshlrev_b32 v38, 16, v205
    v_and_b32 v39, 0xffff0000, v205
    v_mul_f32 v38, s32, v38
    v_mul_f32 v39, s32, v39
    v_cvt_pk_bf16_f32 v205, v38, v39
    v_accvgpr_write_b32 a44, v204
    v_lshlrev_b32 v40, 16, v206
    v_and_b32 v41, 0xffff0000, v206
    v_mul_f32 v40, s32, v40
    v_mul_f32 v41, s32, v41
    v_cvt_pk_bf16_f32 v206, v40, v41
    v_accvgpr_write_b32 a45, v205
    v_lshlrev_b32 v36, 16, v207
    v_and_b32 v37, 0xffff0000, v207
    v_mul_f32 v36, s32, v36
    v_mul_f32 v37, s32, v37
    v_cvt_pk_bf16_f32 v207, v36, v37
    v_accvgpr_write_b32 a46, v206
    v_accvgpr_write_b32 a47, v207
    s_waitcnt lgkmcnt(0)
    v_add_u32 v20, 0, v8
    v_xor_b32 v21, 64, v20
    v_xor_b32 v22, 128, v20
    v_xor_b32 v23, 192, v20
    v_add_u32 v24, 65536, v9
    v_xor_b32 v25, 32, v24
    v_xor_b32 v26, 64, v24
    v_xor_b32 v27, 96, v24
    v_xor_b32 v28, 128, v24
    v_xor_b32 v29, 160, v24
    v_xor_b32 v30, 192, v24
    v_xor_b32 v31, 224, v24
    s_waitcnt vmcnt(8)
    s_barrier
    ds_read_b128 a[48:51], v20
    ds_read_b128 a[52:55], v21
    ds_read_b128 a[56:59], v22
    ds_read_b128 a[60:63], v23
    ds_read_b128 a[64:67], v20 offset:4096
    ds_read_b128 a[68:71], v21 offset:4096
    ds_read_b128 a[72:75], v22 offset:4096
    ds_read_b128 a[76:79], v23 offset:4096
    s_mov_b32 m0, s38
    s_add_u32 s38, s38, 16384
    buffer_load_dwordx4 v2, s[16:19], s36 offen nt lds
    buffer_load_dwordx4 v3, s[16:19], s36 offen offset:1024 nt lds
    buffer_load_dwordx4 v4, s[16:19], s36 offen offset:2048 nt lds
    buffer_load_dwordx4 v5, s[16:19], s36 offen offset:3072 nt lds
    s_add_u32 s36, s36, 16384
    s_and_b32 s38, s38, 0xffff
    s_waitcnt lgkmcnt(7)
    v_mfma_f32_16x16x32_bf16 v[160:163], a[48:51], a[0:3], 0
    s_waitcnt lgkmcnt(6)
    v_mfma_f32_16x16x32_bf16 v[160:163], a[52:55], a[4:7], v[160:163]
    s_waitcnt lgkmcnt(5)
    v_mfma_f32_16x16x32_bf16 v[160:163], a[56:59], a[8:11], v[160:163]
    s_waitcnt lgkmcnt(4)
    v_mfma_f32_16x16x32_bf16 v[160:163], a[60:63], a[12:15], v[160:163]
    v_mfma_f32_16x16x32_bf16 v[168:171], a[48:51], a[16:19], 0
    ds_read_b128 a[112:115], v20 offset:8192
    v_mfma_f32_16x16x32_bf16 v[168:171], a[52:55], a[20:23], v[168:171]
    ds_read_b128 a[116:119], v21 offset:8192
    v_mfma_f32_16x16x32_bf16 v[168:171], a[56:59], a[24:27], v[168:171]
    ds_read_b128 a[120:123], v22 offset:8192
    v_mfma_f32_16x16x32_bf16 v[168:171], a[60:63], a[28:31], v[168:171]
    ds_read_b128 a[124:127], v23 offset:8192
    v_mfma_f32_16x16x32_bf16 v[176:179], a[48:51], a[32:35], 0
    ds_read_b128 a[128:131], v20 offset:12288
    v_mfma_f32_16x16x32_bf16 v[176:179], a[52:55], a[36:39], v[176:179]
    ds_read_b128 a[132:135], v21 offset:12288
    v_mfma_f32_16x16x32_bf16 v[176:179], a[56:59], a[40:43], v[176:179]
    ds_read_b128 a[136:139], v22 offset:12288
    v_mfma_f32_16x16x32_bf16 v[176:179], a[60:63], a[44:47], v[176:179]
    ds_read_b128 a[140:143], v23 offset:12288
    s_waitcnt lgkmcnt(11)
    v_mfma_f32_16x16x32_bf16 v[164:167], a[64:67], a[0:3], 0
    s_waitcnt lgkmcnt(10)
    v_mfma_f32_16x16x32_bf16 v[164:167], a[68:71], a[4:7], v[164:167]
    s_waitcnt lgkmcnt(9)
    v_mfma_f32_16x16x32_bf16 v[164:167], a[72:75], a[8:11], v[164:167]
    s_waitcnt lgkmcnt(8)
    v_mfma_f32_16x16x32_bf16 v[164:167], a[76:79], a[12:15], v[164:167]
    v_mfma_f32_16x16x32_bf16 v[172:175], a[64:67], a[16:19], 0
    v_mfma_f32_16x16x32_bf16 v[172:175], a[68:71], a[20:23], v[172:175]
    v_mfma_f32_16x16x32_bf16 v[172:175], a[72:75], a[24:27], v[172:175]
    v_mfma_f32_16x16x32_bf16 v[172:175], a[76:79], a[28:31], v[172:175]
    v_mfma_f32_16x16x32_bf16 v[180:183], a[64:67], a[32:35], 0
    v_mfma_f32_16x16x32_bf16 v[180:183], a[68:71], a[36:39], v[180:183]
    v_mfma_f32_16x16x32_bf16 v[180:183], a[72:75], a[40:43], v[180:183]
    v_mfma_f32_16x16x32_bf16 v[180:183], a[76:79], a[44:47], v[180:183]
    s_nop 7
    v_max3_f32 v48, v160, v161, v162
    v_max3_f32 v49, v163, v164, v165
    v_max3_f32 v48, v48, v166, v167
    v_max_f32 v48, v48, v49
    v_mov_b32 v49, v48
    s_nop 1
    v_permlane16_swap_b32 v48, v49
    s_nop 1
    v_max_f32 v48, v48, v49
    v_mov_b32 v49, v48
    s_nop 1
    v_permlane32_swap_b32 v48, v49
    s_nop 1
    v_max_f32 v48, v48, v49
    v_mov_b32 v42, v48
    v_sub_f32 v10, v10, v42
    v_mov_b32 v52, v10
    v_mov_b32 v53, v10
    v_mov_b32 v54, v10
    v_mov_b32 v55, v10
    v_sub_f32 v160, v160, v42
    v_sub_f32 v161, v161, v42
    v_sub_f32 v162, v162, v42
    v_sub_f32 v163, v163, v42
    v_sub_f32 v164, v164, v42
    v_sub_f32 v165, v165, v42
    v_sub_f32 v166, v166, v42
    v_sub_f32 v167, v167, v42
    v_max3_f32 v48, v168, v169, v170
    v_max3_f32 v49, v171, v172, v173
    v_max3_f32 v48, v48, v174, v175
    v_max_f32 v48, v48, v49
    v_mov_b32 v49, v48
    s_nop 1
    v_permlane16_swap_b32 v48, v49
    s_nop 1
    v_max_f32 v48, v48, v49
    v_mov_b32 v49, v48
    s_nop 1
    v_permlane32_swap_b32 v48, v49
    s_nop 1
    v_max_f32 v48, v48, v49
    v_mov_b32 v43, v48
    v_sub_f32 v11, v11, v43
    v_mov_b32 v56, v11
    v_mov_b32 v57, v11
    v_mov_b32 v58, v11
    v_mov_b32 v59, v11
    v_sub_f32 v168, v168, v43
    v_sub_f32 v169, v169, v43
    v_sub_f32 v170, v170, v43
    v_sub_f32 v171, v171, v43
    v_sub_f32 v172, v172, v43
    v_sub_f32 v173, v173, v43
    v_sub_f32 v174, v174, v43
    v_sub_f32 v175, v175, v43
    v_max3_f32 v48, v176, v177, v178
    v_max3_f32 v49, v179, v180, v181
    v_max3_f32 v48, v48, v182, v183
    v_max_f32 v48, v48, v49
    v_mov_b32 v49, v48
    s_nop 1
    v_permlane16_swap_b32 v48, v49
    s_nop 1
    v_max_f32 v48, v48, v49
    v_mov_b32 v49, v48
    s_nop 1
    v_permlane32_swap_b32 v48, v49
    s_nop 1
    v_max_f32 v48, v48, v49
    v_mov_b32 v44, v48
    v_sub_f32 v12, v12, v44
    v_mov_b32 v60, v12
    v_mov_b32 v61, v12
    v_mov_b32 v62, v12
    v_mov_b32 v63, v12
    v_sub_f32 v176, v176, v44
    v_sub_f32 v177, v177, v44
    v_sub_f32 v178, v178, v44
    v_sub_f32 v179, v179, v44
    v_sub_f32 v180, v180, v44
    v_sub_f32 v181, v181, v44
    v_sub_f32 v182, v182, v44
    v_sub_f32 v183, v183, v44
    s_nop 0
    s_waitcnt lgkmcnt(4)
    v_mfma_f32_16x16x32_bf16 v[184:187], a[112:115], a[0:3], v[52:55]
    v_exp_f32 v36, v160
    v_exp_f32 v37, v161
    v_mfma_f32_16x16x32_bf16 v[184:187], a[116:119], a[4:7], v[184:187]
    v_exp_f32 v38, v162
    v_cvt_pk_bf16_f32 v208, v36, v37
    v_add_f32 v13, v13, v36
    v_mfma_f32_16x16x32_bf16 v[184:187], a[120:123], a[8:11], v[184:187]
    s_add_u32 m0, s39, 65536
    s_add_u32 s39, s39, 16384
    buffer_load_dwordx4 v6, s[20:23], s37 offen nt lds
    buffer_load_dwordx4 v7, s[20:23], s37 offen offset:1024 nt lds
    buffer_load_dwordx4 v6, s[20:23], s37 offen offset:2048 nt lds
    buffer_load_dwordx4 v7, s[20:23], s37 offen offset:3072 nt lds
    s_add_u32 s37, s37, 16384
    s_and_b32 s39, s39, 0xffff
    v_mfma_f32_16x16x32_bf16 v[184:187], a[124:127], a[12:15], v[184:187]
    v_exp_f32 v39, v163
    v_mfma_f32_16x16x32_bf16 v[192:195], a[112:115], a[16:19], v[56:59]
    v_add_f32 v13, v13, v37
    v_mfma_f32_16x16x32_bf16 v[192:195], a[116:119], a[20:23], v[192:195]
    v_exp_f32 v40, v164
    v_cvt_pk_bf16_f32 v209, v38, v39
    v_mfma_f32_16x16x32_bf16 v[192:195], a[120:123], a[24:27], v[192:195]
    v_add_f32 v13, v13, v38
    v_exp_f32 v41, v165
    v_add_f32 v13, v13, v39
    v_mfma_f32_16x16x32_bf16 v[192:195], a[124:127], a[28:31], v[192:195]
    v_exp_f32 v36, v166
    v_cvt_pk_bf16_f32 v210, v40, v41
    v_add_f32 v13, v13, v40
    v_mfma_f32_16x16x32_bf16 v[200:203], a[112:115], a[32:35], v[60:63]
    v_exp_f32 v37, v167
    v_add_f32 v13, v13, v41
    v_exp_f32 v38, v168
    v_cvt_pk_bf16_f32 v211, v36, v37
    v_mfma_f32_16x16x32_bf16 v[200:203], a[116:119], a[36:39], v[200:203]
    v_add_f32 v13, v13, v36
    v_exp_f32 v39, v169
    v_add_f32 v13, v13, v37
    v_mfma_f32_16x16x32_bf16 v[200:203], a[120:123], a[40:43], v[200:203]
    v_exp_f32 v40, v170
    v_cvt_pk_bf16_f32 v212, v38, v39
    v_add_f32 v14, v14, v38
    v_mfma_f32_16x16x32_bf16 v[200:203], a[124:127], a[44:47], v[200:203]
    v_exp_f32 v41, v171
    v_add_f32 v14, v14, v39
    s_waitcnt lgkmcnt(0)
    v_mfma_f32_16x16x32_bf16 v[188:191], a[128:131], a[0:3], v[52:55]
    v_exp_f32 v36, v172
    v_cvt_pk_bf16_f32 v213, v40, v41
    v_add_f32 v14, v14, v40
    v_mfma_f32_16x16x32_bf16 v[188:191], a[132:135], a[4:7], v[188:191]
    v_exp_f32 v37, v173
    v_add_f32 v14, v14, v41
    v_exp_f32 v38, v174
    v_cvt_pk_bf16_f32 v214, v36, v37
    v_mfma_f32_16x16x32_bf16 v[188:191], a[136:139], a[8:11], v[188:191]
    v_add_f32 v14, v14, v36
    v_exp_f32 v39, v175
    v_add_f32 v14, v14, v37
    v_mfma_f32_16x16x32_bf16 v[188:191], a[140:143], a[12:15], v[188:191]
    v_exp_f32 v40, v176
    v_cvt_pk_bf16_f32 v215, v38, v39
    v_add_f32 v14, v14, v38
    v_mfma_f32_16x16x32_bf16 v[196:199], a[128:131], a[16:19], v[56:59]
    v_exp_f32 v41, v177
    v_add_f32 v14, v14, v39
    v_exp_f32 v36, v178
    v_mfma_f32_16x16x32_bf16 v[196:199], a[132:135], a[20:23], v[196:199]
    v_cvt_pk_bf16_f32 v216, v40, v41
    v_add_f32 v15, v15, v40
    v_exp_f32 v37, v179
    v_add_f32 v15, v15, v41
    v_mfma_f32_16x16x32_bf16 v[196:199], a[136:139], a[24:27], v[196:199]
    v_exp_f32 v38, v180
    v_cvt_pk_bf16_f32 v217, v36, v37
    v_add_f32 v15, v15, v36
    v_mfma_f32_16x16x32_bf16 v[196:199], a[140:143], a[28:31], v[196:199]
    v_exp_f32 v39, v181
    v_add_f32 v15, v15, v37
    v_exp_f32 v40, v182
    v_mfma_f32_16x16x32_bf16 v[204:207], a[128:131], a[32:35], v[60:63]
    v_cvt_pk_bf16_f32 v218, v38, v39
    v_add_f32 v15, v15, v38
    v_exp_f32 v41, v183
    v_mfma_f32_16x16x32_bf16 v[204:207], a[132:135], a[36:39], v[204:207]
    v_add_f32 v15, v15, v39
    v_add_f32 v15, v15, v40
    v_add_f32 v15, v15, v41
    v_cvt_pk_bf16_f32 v219, v40, v41
    v_mfma_f32_16x16x32_bf16 v[204:207], a[136:139], a[40:43], v[204:207]
    v_mfma_f32_16x16x32_bf16 v[204:207], a[140:143], a[44:47], v[204:207]
    s_cmp_lt_u32 s34, 5
    s_cbranch_scc1 L_lb1
    s_mov_b32 m0, s38
    s_add_u32 s38, s38, 16384
    buffer_load_dwordx4 v2, s[16:19], s36 offen nt lds
    buffer_load_dwordx4 v3, s[16:19], s36 offen offset:1024 nt lds
    buffer_load_dwordx4 v4, s[16:19], s36 offen offset:2048 nt lds
    buffer_load_dwordx4 v5, s[16:19], s36 offen offset:3072 nt lds
    s_add_u32 s36, s36, 16384
    s_and_b32 s38, s38, 0xffff
    s_add_u32 m0, s39, 65536
    s_add_u32 s39, s39, 16384
    buffer_load_dwordx4 v6, s[20:23], s37 offen nt lds
    buffer_load_dwordx4 v7, s[20:23], s37 offen offset:1024 nt lds
    buffer_load_dwordx4 v6, s[20:23], s37 offen offset:2048 nt lds
    buffer_load_dwordx4 v7, s[20:23], s37 offen offset:3072 nt lds
    s_add_u32 s37, s37, 16384
    s_and_b32 s39, s39, 0xffff
    s_waitcnt vmcnt(0)
L_lb1:
    s_waitcnt vmcnt(8) lgkmcnt(0)
    s_barrier
    ds_read_b128 a[48:51], v20 offset:16384
    ds_read_b128 a[52:55], v21 offset:16384
    ds_read_b128 a[56:59], v22 offset:16384
    ds_read_b128 a[60:63], v23 offset:16384
    ds_read_b128 a[64:67], v20 offset:20480
    ds_read_b128 a[68:71], v21 offset:20480
    ds_read_b128 a[72:75], v22 offset:20480
    ds_read_b128 a[76:79], v23 offset:20480
    s_waitcnt lgkmcnt(4)
    v_mfma_f32_16x16x32_bf16 v[160:163], a[48:51], a[0:3], v[52:55]
    ds_read_b64_tr_b16 a[80:81], v24
    v_exp_f32 v36, v184
    v_mfma_f32_16x16x32_bf16 v[160:163], a[52:55], a[4:7], v[160:163]
    ds_read_b64_tr_b16 a[82:83], v24 offset:4096
    v_exp_f32 v37, v185
    v_mfma_f32_16x16x32_bf16 v[160:163], a[56:59], a[8:11], v[160:163]
    s_cmp_ge_u32 s34, 5
    s_cbranch_scc1 L_nd2
    s_mov_b32 m0, s38
    s_add_u32 s38, s38, 16384
    buffer_load_dwordx4 v2, s[16:19], s36 offen nt lds
    buffer_load_dwordx4 v3, s[16:19], s36 offen offset:1024 nt lds
    buffer_load_dwordx4 v4, s[16:19], s36 offen offset:2048 nt lds
    buffer_load_dwordx4 v5, s[16:19], s36 offen offset:3072 nt lds
    s_add_u32 s36, s36, 16384
    s_and_b32 s38, s38, 0xffff
L_nd2:
    v_mfma_f32_16x16x32_bf16 v[160:163], a[60:63], a[12:15], v[160:163]
    ds_read_b64_tr_b16 a[84:85], v25
    v_mfma_f32_16x16x32_bf16 v[168:171], a[48:51], a[16:19], v[56:59]
    ds_read_b64_tr_b16 a[86:87], v25 offset:4096
    v_mfma_f32_16x16x32_bf16 v[168:171], a[52:55], a[20:23], v[168:171]
    v_exp_f32 v38, v186
    v_mfma_f32_16x16x32_bf16 v[168:171], a[56:59], a[24:27], v[168:171]
    ds_read_b64_tr_b16 a[88:89], v26
    v_cvt_pk_bf16_f32 v220, v36, v37
    v_mfma_f32_16x16x32_bf16 v[168:171], a[60:63], a[28:31], v[168:171]
    ds_read_b64_tr_b16 a[90:91], v26 offset:4096
    v_add_f32 v13, v13, v36
    v_mfma_f32_16x16x32_bf16 v[176:179], a[48:51], a[32:35], v[60:63]
    v_exp_f32 v39, v187
    v_mfma_f32_16x16x32_bf16 v[176:179], a[52:55], a[36:39], v[176:179]
    ds_read_b64_tr_b16 a[92:93], v27
    v_add_f32 v13, v13, v37
    v_mfma_f32_16x16x32_bf16 v[176:179], a[56:59], a[40:43], v[176:179]
    ds_read_b64_tr_b16 a[94:95], v27 offset:4096
    v_mfma_f32_16x16x32_bf16 v[176:179], a[60:63], a[44:47], v[176:179]
    s_waitcnt lgkmcnt(8)
    v_mfma_f32_16x16x32_bf16 v[164:167], a[64:67], a[0:3], v[52:55]
    ds_read_b64_tr_b16 a[96:97], v28
    v_mfma_f32_16x16x32_bf16 v[164:167], a[68:71], a[4:7], v[164:167]
    ds_read_b64_tr_b16 a[98:99], v28 offset:4096
    v_exp_f32 v40, v188
    v_mfma_f32_16x16x32_bf16 v[164:167], a[72:75], a[8:11], v[164:167]
    v_cvt_pk_bf16_f32 v221, v38, v39
    v_add_f32 v13, v13, v38
    v_mfma_f32_16x16x32_bf16 v[164:167], a[76:79], a[12:15], v[164:167]
    ds_read_b64_tr_b16 a[100:101], v29
    v_exp_f32 v41, v189
    v_mfma_f32_16x16x32_bf16 v[172:175], a[64:67], a[16:19], v[56:59]
    ds_read_b64_tr_b16 a[102:103], v29 offset:4096
    v_add_f32 v13, v13, v39
    v_mfma_f32_16x16x32_bf16 v[172:175], a[68:71], a[20:23], v[172:175]
    v_exp_f32 v36, v190
    v_cvt_pk_bf16_f32 v222, v40, v41
    v_mfma_f32_16x16x32_bf16 v[172:175], a[72:75], a[24:27], v[172:175]
    ds_read_b64_tr_b16 a[104:105], v30
    v_add_f32 v13, v13, v40
    v_mfma_f32_16x16x32_bf16 v[172:175], a[76:79], a[28:31], v[172:175]
    ds_read_b64_tr_b16 a[106:107], v30 offset:4096
    v_exp_f32 v37, v191
    v_mfma_f32_16x16x32_bf16 v[180:183], a[64:67], a[32:35], v[60:63]
    v_add_f32 v13, v13, v41
    v_exp_f32 v38, v192
    v_mfma_f32_16x16x32_bf16 v[180:183], a[68:71], a[36:39], v[180:183]
    ds_read_b64_tr_b16 a[108:109], v31
    v_cvt_pk_bf16_f32 v223, v36, v37
    v_mfma_f32_16x16x32_bf16 v[180:183], a[72:75], a[40:43], v[180:183]
    ds_read_b64_tr_b16 a[110:111], v31 offset:4096
    v_add_f32 v13, v13, v36
    v_mfma_f32_16x16x32_bf16 v[180:183], a[76:79], a[44:47], v[180:183]
    v_exp_f32 v39, v193
    s_waitcnt lgkmcnt(8)
    v_mfma_f32_16x16x32_bf16 v[64:67], a[80:83], v[208:211], v[64:67]
    v_add_f32 v13, v13, v37
    v_exp_f32 v40, v194
    v_mfma_f32_16x16x32_bf16 v[68:71], a[80:83], v[212:215], v[68:71]
    v_cvt_pk_bf16_f32 v224, v38, v39
    v_add_f32 v14, v14, v38
    v_mfma_f32_16x16x32_bf16 v[72:75], a[80:83], v[216:219], v[72:75]
    v_exp_f32 v41, v195
    v_add_f32 v14, v14, v39
    v_mfma_f32_16x16x32_bf16 v[76:79], a[84:87], v[208:211], v[76:79]
    v_exp_f32 v36, v196
    v_cvt_pk_bf16_f32 v225, v40, v41
    v_mfma_f32_16x16x32_bf16 v[80:83], a[84:87], v[212:215], v[80:83]
    v_add_f32 v14, v14, v40
    v_exp_f32 v37, v197
    v_mfma_f32_16x16x32_bf16 v[84:87], a[84:87], v[216:219], v[84:87]
    v_add_f32 v14, v14, v41
    v_mfma_f32_16x16x32_bf16 v[88:91], a[88:91], v[208:211], v[88:91]
    v_exp_f32 v38, v198
    v_cvt_pk_bf16_f32 v226, v36, v37
    v_mfma_f32_16x16x32_bf16 v[92:95], a[88:91], v[212:215], v[92:95]
    v_add_f32 v14, v14, v36
    v_exp_f32 v39, v199
    v_mfma_f32_16x16x32_bf16 v[96:99], a[88:91], v[216:219], v[96:99]
    v_add_f32 v14, v14, v37
    v_exp_f32 v40, v200
    v_mfma_f32_16x16x32_bf16 v[100:103], a[92:95], v[208:211], v[100:103]
    v_cvt_pk_bf16_f32 v227, v38, v39
    v_add_f32 v14, v14, v38
    v_mfma_f32_16x16x32_bf16 v[104:107], a[92:95], v[212:215], v[104:107]
    ds_read_b128 a[48:51], v20 offset:24576
    v_exp_f32 v41, v201
    v_mfma_f32_16x16x32_bf16 v[108:111], a[92:95], v[216:219], v[108:111]
    ds_read_b128 a[52:55], v21 offset:24576
    s_waitcnt lgkmcnt(2)
    v_mfma_f32_16x16x32_bf16 v[112:115], a[96:99], v[208:211], v[112:115]
    ds_read_b128 a[56:59], v22 offset:24576
    v_add_f32 v14, v14, v39
    v_mfma_f32_16x16x32_bf16 v[116:119], a[96:99], v[212:215], v[116:119]
    v_exp_f32 v36, v202
    v_cvt_pk_bf16_f32 v228, v40, v41
    v_mfma_f32_16x16x32_bf16 v[120:123], a[96:99], v[216:219], v[120:123]
    ds_read_b128 a[60:63], v23 offset:24576
    v_add_f32 v15, v15, v40
    v_mfma_f32_16x16x32_bf16 v[124:127], a[100:103], v[208:211], v[124:127]
    v_exp_f32 v37, v203
    v_add_f32 v15, v15, v41
    v_mfma_f32_16x16x32_bf16 v[128:131], a[100:103], v[212:215], v[128:131]
    ds_read_b128 a[64:67], v20 offset:28672
    v_exp_f32 v38, v204
    v_mfma_f32_16x16x32_bf16 v[132:135], a[100:103], v[216:219], v[132:135]
    v_cvt_pk_bf16_f32 v229, v36, v37
    v_add_f32 v15, v15, v36
    v_mfma_f32_16x16x32_bf16 v[136:139], a[104:107], v[208:211], v[136:139]
    ds_read_b128 a[68:71], v21 offset:28672
    v_exp_f32 v39, v205
    v_mfma_f32_16x16x32_bf16 v[140:143], a[104:107], v[212:215], v[140:143]
    v_add_f32 v15, v15, v37
    v_exp_f32 v40, v206
    v_mfma_f32_16x16x32_bf16 v[144:147], a[104:107], v[216:219], v[144:147]
    ds_read_b128 a[72:75], v22 offset:28672
    v_cvt_pk_bf16_f32 v230, v38, v39
    v_mfma_f32_16x16x32_bf16 v[148:151], a[108:111], v[208:211], v[148:151]
    v_add_f32 v15, v15, v38
    v_exp_f32 v41, v207
    v_mfma_f32_16x16x32_bf16 v[152:155], a[108:111], v[212:215], v[152:155]
    ds_read_b128 a[76:79], v23 offset:28672
    v_add_f32 v15, v15, v39
    v_mfma_f32_16x16x32_bf16 v[156:159], a[108:111], v[216:219], v[156:159]
    v_add_f32 v15, v15, v40
    v_add_f32 v15, v15, v41
    v_cvt_pk_bf16_f32 v231, v40, v41
    s_waitcnt lgkmcnt(4)
    v_mfma_f32_16x16x32_bf16 v[184:187], a[48:51], a[0:3], v[52:55]
    ds_read_b64_tr_b16 a[80:81], v24 offset:8192
    v_xor_b32 v20, 0x8000, v20
    v_xor_b32 v21, 0x8000, v21
    v_mfma_f32_16x16x32_bf16 v[184:187], a[52:55], a[4:7], v[184:187]
    ds_read_b64_tr_b16 a[82:83], v24 offset:12288
    v_xor_b32 v22, 0x8000, v22
    v_mfma_f32_16x16x32_bf16 v[184:187], a[56:59], a[8:11], v[184:187]
    s_cmp_ge_u32 s34, 5
    s_cbranch_scc1 L_nd3
    s_add_u32 m0, s39, 65536
    s_add_u32 s39, s39, 16384
    buffer_load_dwordx4 v6, s[20:23], s37 offen nt lds
    buffer_load_dwordx4 v7, s[20:23], s37 offen offset:1024 nt lds
    buffer_load_dwordx4 v6, s[20:23], s37 offen offset:2048 nt lds
    buffer_load_dwordx4 v7, s[20:23], s37 offen offset:3072 nt lds
    s_add_u32 s37, s37, 16384
    s_and_b32 s39, s39, 0xffff
L_nd3:
    v_mfma_f32_16x16x32_bf16 v[184:187], a[60:63], a[12:15], v[184:187]
    ds_read_b64_tr_b16 a[84:85], v25 offset:8192
    v_xor_b32 v23, 0x8000, v23
    v_mfma_f32_16x16x32_bf16 v[192:195], a[48:51], a[16:19], v[56:59]
    ds_read_b64_tr_b16 a[86:87], v25 offset:12288
    v_mfma_f32_16x16x32_bf16 v[192:195], a[52:55], a[20:23], v[192:195]
    v_exp_f32 v36, v160
    v_mfma_f32_16x16x32_bf16 v[192:195], a[56:59], a[24:27], v[192:195]
    ds_read_b64_tr_b16 a[88:89], v26 offset:8192
    v_mfma_f32_16x16x32_bf16 v[192:195], a[60:63], a[28:31], v[192:195]
    ds_read_b64_tr_b16 a[90:91], v26 offset:12288
    v_mfma_f32_16x16x32_bf16 v[200:203], a[48:51], a[32:35], v[60:63]
    v_exp_f32 v37, v161
    v_mfma_f32_16x16x32_bf16 v[200:203], a[52:55], a[36:39], v[200:203]
    ds_read_b64_tr_b16 a[92:93], v27 offset:8192
    v_mfma_f32_16x16x32_bf16 v[200:203], a[56:59], a[40:43], v[200:203]
    ds_read_b64_tr_b16 a[94:95], v27 offset:12288
    v_exp_f32 v38, v162
    v_mfma_f32_16x16x32_bf16 v[200:203], a[60:63], a[44:47], v[200:203]
    v_cvt_pk_bf16_f32 v208, v36, v37
    s_waitcnt lgkmcnt(8)
    v_mfma_f32_16x16x32_bf16 v[188:191], a[64:67], a[0:3], v[52:55]
    ds_read_b64_tr_b16 a[96:97], v28 offset:8192
    v_add_f32 v13, v13, v36
    v_mfma_f32_16x16x32_bf16 v[188:191], a[68:71], a[4:7], v[188:191]
    ds_read_b64_tr_b16 a[98:99], v28 offset:12288
    v_exp_f32 v39, v163
    v_mfma_f32_16x16x32_bf16 v[188:191], a[72:75], a[8:11], v[188:191]
    v_add_f32 v13, v13, v37
    v_exp_f32 v40, v164
    v_mfma_f32_16x16x32_bf16 v[188:191], a[76:79], a[12:15], v[188:191]
    ds_read_b64_tr_b16 a[100:101], v29 offset:8192
    v_cvt_pk_bf16_f32 v209, v38, v39
    v_add_f32 v13, v13, v38
    v_mfma_f32_16x16x32_bf16 v[196:199], a[64:67], a[16:19], v[56:59]
    ds_read_b64_tr_b16 a[102:103], v29 offset:12288
    v_exp_f32 v41, v165
    v_mfma_f32_16x16x32_bf16 v[196:199], a[68:71], a[20:23], v[196:199]
    v_add_f32 v13, v13, v39
    v_exp_f32 v36, v166
    v_mfma_f32_16x16x32_bf16 v[196:199], a[72:75], a[24:27], v[196:199]
    ds_read_b64_tr_b16 a[104:105], v30 offset:8192
    v_cvt_pk_bf16_f32 v210, v40, v41
    v_mfma_f32_16x16x32_bf16 v[196:199], a[76:79], a[28:31], v[196:199]
    ds_read_b64_tr_b16 a[106:107], v30 offset:12288
    v_add_f32 v13, v13, v40
    v_mfma_f32_16x16x32_bf16 v[204:207], a[64:67], a[32:35], v[60:63]
    v_exp_f32 v37, v167
    v_add_f32 v13, v13, v41
    v_mfma_f32_16x16x32_bf16 v[204:207], a[68:71], a[36:39], v[204:207]
    ds_read_b64_tr_b16 a[108:109], v31 offset:8192
    v_exp_f32 v38, v168
    v_mfma_f32_16x16x32_bf16 v[204:207], a[72:75], a[40:43], v[204:207]
    ds_read_b64_tr_b16 a[110:111], v31 offset:12288
    v_cvt_pk_bf16_f32 v211, v36, v37
    v_add_f32 v13, v13, v36
    v_mfma_f32_16x16x32_bf16 v[204:207], a[76:79], a[44:47], v[204:207]
    v_exp_f32 v39, v169
    s_waitcnt lgkmcnt(8)
    v_mfma_f32_16x16x32_bf16 v[64:67], a[80:83], v[220:223], v[64:67]
    v_add_f32 v13, v13, v37
    v_exp_f32 v40, v170
    v_mfma_f32_16x16x32_bf16 v[68:71], a[80:83], v[224:227], v[68:71]
    v_cvt_pk_bf16_f32 v212, v38, v39
    v_add_f32 v14, v14, v38
    v_mfma_f32_16x16x32_bf16 v[72:75], a[80:83], v[228:231], v[72:75]
    v_exp_f32 v41, v171
    v_add_f32 v14, v14, v39
    v_mfma_f32_16x16x32_bf16 v[76:79], a[84:87], v[220:223], v[76:79]
    v_exp_f32 v36, v172
    v_mfma_f32_16x16x32_bf16 v[80:83], a[84:87], v[224:227], v[80:83]
    v_cvt_pk_bf16_f32 v213, v40, v41
    v_add_f32 v14, v14, v40
    v_mfma_f32_16x16x32_bf16 v[84:87], a[84:87], v[228:231], v[84:87]
    v_exp_f32 v37, v173
    v_add_f32 v14, v14, v41
    v_mfma_f32_16x16x32_bf16 v[88:91], a[88:91], v[220:223], v[88:91]
    v_exp_f32 v38, v174
    v_cvt_pk_bf16_f32 v214, v36, v37
    v_mfma_f32_16x16x32_bf16 v[92:95], a[88:91], v[224:227], v[92:95]
    v_add_f32 v14, v14, v36
    v_exp_f32 v39, v175
    v_mfma_f32_16x16x32_bf16 v[96:99], a[88:91], v[228:231], v[96:99]
    v_add_f32 v14, v14, v37
    v_exp_f32 v40, v176
    v_mfma_f32_16x16x32_bf16 v[100:103], a[92:95], v[220:223], v[100:103]
    v_cvt_pk_bf16_f32 v215, v38, v39
    v_add_f32 v14, v14, v38
    v_mfma_f32_16x16x32_bf16 v[104:107], a[92:95], v[224:227], v[104:107]
    s_waitcnt vmcnt(8) lgkmcnt(0)
    s_barrier
    ds_read_b128 a[48:51], v20
    v_mfma_f32_16x16x32_bf16 v[108:111], a[92:95], v[228:231], v[108:111]
    ds_read_b128 a[52:55], v21
    v_mfma_f32_16x16x32_bf16 v[112:115], a[96:99], v[220:223], v[112:115]
    ds_read_b128 a[56:59], v22
    v_exp_f32 v41, v177
    v_mfma_f32_16x16x32_bf16 v[116:119], a[96:99], v[224:227], v[116:119]
    v_add_f32 v14, v14, v39
    v_exp_f32 v36, v178
    v_mfma_f32_16x16x32_bf16 v[120:123], a[96:99], v[228:231], v[120:123]
    ds_read_b128 a[60:63], v23
    v_cvt_pk_bf16_f32 v216, v40, v41
    v_add_f32 v15, v15, v40
    v_mfma_f32_16x16x32_bf16 v[124:127], a[100:103], v[220:223], v[124:127]
    v_exp_f32 v37, v179
    v_add_f32 v15, v15, v41
    v_mfma_f32_16x16x32_bf16 v[128:131], a[100:103], v[224:227], v[128:131]
    ds_read_b128 a[64:67], v20 offset:4096
    v_exp_f32 v38, v180
    v_mfma_f32_16x16x32_bf16 v[132:135], a[100:103], v[228:231], v[132:135]
    v_cvt_pk_bf16_f32 v217, v36, v37
    v_add_f32 v15, v15, v36
    v_mfma_f32_16x16x32_bf16 v[136:139], a[104:107], v[220:223], v[136:139]
    ds_read_b128 a[68:71], v21 offset:4096
    v_exp_f32 v39, v181
    v_mfma_f32_16x16x32_bf16 v[140:143], a[104:107], v[224:227], v[140:143]
    v_add_f32 v15, v15, v37
    v_exp_f32 v40, v182
    v_mfma_f32_16x16x32_bf16 v[144:147], a[104:107], v[228:231], v[144:147]
    ds_read_b128 a[72:75], v22 offset:4096
    v_cvt_pk_bf16_f32 v218, v38, v39
    v_mfma_f32_16x16x32_bf16 v[148:151], a[108:111], v[220:223], v[148:151]
    v_add_f32 v15, v15, v38
    v_exp_f32 v41, v183
    v_mfma_f32_16x16x32_bf16 v[152:155], a[108:111], v[224:227], v[152:155]
    ds_read_b128 a[76:79], v23 offset:4096
    v_add_f32 v15, v15, v39
    v_mfma_f32_16x16x32_bf16 v[156:159], a[108:111], v[228:231], v[156:159]
    v_add_f32 v15, v15, v40
    v_add_f32 v15, v15, v41
    v_cvt_pk_bf16_f32 v219, v40, v41
    s_mov_b32 s29, 2
.p2align 6
L_loop:
    s_waitcnt lgkmcnt(4)
    v_mfma_f32_16x16x32_bf16 v[160:163], a[48:51], a[0:3], v[52:55]
    ds_read_b64_tr_b16 a[80:81], v24 offset:16384
    v_exp_f32 v36, v184
    v_mfma_f32_16x16x32_bf16 v[160:163], a[52:55], a[4:7], v[160:163]
    ds_read_b64_tr_b16 a[82:83], v24 offset:20480
    v_mfma_f32_16x16x32_bf16 v[160:163], a[56:59], a[8:11], v[160:163]
    s_mov_b32 m0, s38
    s_add_u32 s38, s38, 16384
    v_mfma_f32_16x16x32_bf16 v[160:163], a[60:63], a[12:15], v[160:163]
    ds_read_b64_tr_b16 a[84:85], v25 offset:16384
    buffer_load_dwordx4 v2, s[16:19], s36 offen nt lds
    v_mfma_f32_16x16x32_bf16 v[168:171], a[48:51], a[16:19], v[56:59]
    ds_read_b64_tr_b16 a[86:87], v25 offset:20480
    v_exp_f32 v37, v185
    v_mfma_f32_16x16x32_bf16 v[168:171], a[52:55], a[20:23], v[168:171]
    buffer_load_dwordx4 v3, s[16:19], s36 offen offset:1024 nt lds
    v_exp_f32 v38, v186
    v_mfma_f32_16x16x32_bf16 v[168:171], a[56:59], a[24:27], v[168:171]
    ds_read_b64_tr_b16 a[88:89], v26 offset:16384
    v_cvt_pk_bf16_f32 v220, v36, v37
    v_add_f32 v13, v13, v36
    v_mfma_f32_16x16x32_bf16 v[168:171], a[60:63], a[28:31], v[168:171]
    ds_read_b64_tr_b16 a[90:91], v26 offset:20480
    buffer_load_dwordx4 v4, s[16:19], s36 offen offset:2048 nt lds
    v_mfma_f32_16x16x32_bf16 v[176:179], a[48:51], a[32:35], v[60:63]
    v_exp_f32 v39, v187
    v_add_f32 v13, v13, v37
    v_mfma_f32_16x16x32_bf16 v[176:179], a[52:55], a[36:39], v[176:179]
    ds_read_b64_tr_b16 a[92:93], v27 offset:16384
    buffer_load_dwordx4 v5, s[16:19], s36 offen offset:3072 nt lds
    v_mfma_f32_16x16x32_bf16 v[176:179], a[56:59], a[40:43], v[176:179]
    ds_read_b64_tr_b16 a[94:95], v27 offset:20480
    s_add_u32 s36, s36, 16384
    s_and_b32 s38, s38, 0xffff
    v_mfma_f32_16x16x32_bf16 v[176:179], a[60:63], a[44:47], v[176:179]
    v_exp_f32 v40, v188
    s_waitcnt lgkmcnt(8)
    v_mfma_f32_16x16x32_bf16 v[164:167], a[64:67], a[0:3], v[52:55]
    ds_read_b64_tr_b16 a[96:97], v28 offset:16384
    v_cvt_pk_bf16_f32 v221, v38, v39
    v_mfma_f32_16x16x32_bf16 v[164:167], a[68:71], a[4:7], v[164:167]
    ds_read_b64_tr_b16 a[98:99], v28 offset:20480
    v_add_f32 v13, v13, v38
    v_mfma_f32_16x16x32_bf16 v[164:167], a[72:75], a[8:11], v[164:167]
    v_exp_f32 v41, v189
    v_add_f32 v13, v13, v39
    v_mfma_f32_16x16x32_bf16 v[164:167], a[76:79], a[12:15], v[164:167]
    ds_read_b64_tr_b16 a[100:101], v29 offset:16384
    v_exp_f32 v36, v190
    v_mfma_f32_16x16x32_bf16 v[172:175], a[64:67], a[16:19], v[56:59]
    ds_read_b64_tr_b16 a[102:103], v29 offset:20480
    v_cvt_pk_bf16_f32 v222, v40, v41
    v_mfma_f32_16x16x32_bf16 v[172:175], a[68:71], a[20:23], v[172:175]
    v_add_f32 v13, v13, v40
    v_exp_f32 v37, v191
    v_mfma_f32_16x16x32_bf16 v[172:175], a[72:75], a[24:27], v[172:175]
    ds_read_b64_tr_b16 a[104:105], v30 offset:16384
    v_add_f32 v13, v13, v41
    v_mfma_f32_16x16x32_bf16 v[172:175], a[76:79], a[28:31], v[172:175]
    ds_read_b64_tr_b16 a[106:107], v30 offset:20480
    v_exp_f32 v38, v192
    v_mfma_f32_16x16x32_bf16 v[180:183], a[64:67], a[32:35], v[60:63]
    v_cvt_pk_bf16_f32 v223, v36, v37
    v_add_f32 v13, v13, v36
    v_mfma_f32_16x16x32_bf16 v[180:183], a[68:71], a[36:39], v[180:183]
    ds_read_b64_tr_b16 a[108:109], v31 offset:16384
    v_exp_f32 v39, v193
    v_mfma_f32_16x16x32_bf16 v[180:183], a[72:75], a[40:43], v[180:183]
    ds_read_b64_tr_b16 a[110:111], v31 offset:20480
    v_add_f32 v13, v13, v37
    v_mfma_f32_16x16x32_bf16 v[180:183], a[76:79], a[44:47], v[180:183]
    v_exp_f32 v40, v194
    s_waitcnt lgkmcnt(8)
    v_mfma_f32_16x16x32_bf16 v[64:67], a[80:83], v[208:211], v[64:67]
    v_cvt_pk_bf16_f32 v224, v38, v39
    v_add_f32 v14, v14, v38
    v_mfma_f32_16x16x32_bf16 v[68:71], a[80:83], v[212:215], v[68:71]
    v_exp_f32 v41, v195
    v_mfma_f32_16x16x32_bf16 v[72:75], a[80:83], v[216:219], v[72:75]
    v_add_f32 v14, v14, v39
    v_exp_f32 v36, v196
    v_mfma_f32_16x16x32_bf16 v[76:79], a[84:87], v[208:211], v[76:79]
    v_cvt_pk_bf16_f32 v225, v40, v41
    v_add_f32 v14, v14, v40
    v_mfma_f32_16x16x32_bf16 v[80:83], a[84:87], v[212:215], v[80:83]
    v_exp_f32 v37, v197
    v_add_f32 v14, v14, v41
    v_mfma_f32_16x16x32_bf16 v[84:87], a[84:87], v[216:219], v[84:87]
    v_exp_f32 v38, v198
    v_mfma_f32_16x16x32_bf16 v[88:91], a[88:91], v[208:211], v[88:91]
    v_cvt_pk_bf16_f32 v226, v36, v37
    v_add_f32 v14, v14, v36
    v_mfma_f32_16x16x32_bf16 v[92:95], a[88:91], v[212:215], v[92:95]
    v_exp_f32 v39, v199
    v_add_f32 v14, v14, v37
    v_mfma_f32_16x16x32_bf16 v[96:99], a[88:91], v[216:219], v[96:99]
    v_exp_f32 v40, v200
    v_cvt_pk_bf16_f32 v227, v38, v39
    v_mfma_f32_16x16x32_bf16 v[100:103], a[92:95], v[208:211], v[100:103]
    v_add_f32 v14, v14, v38
    v_exp_f32 v41, v201
    v_mfma_f32_16x16x32_bf16 v[104:107], a[92:95], v[212:215], v[104:107]
    ds_read_b128 a[48:51], v20 offset:8192
    v_add_f32 v14, v14, v39
    v_mfma_f32_16x16x32_bf16 v[108:111], a[92:95], v[216:219], v[108:111]
    ds_read_b128 a[52:55], v21 offset:8192
    s_waitcnt lgkmcnt(2)
    v_mfma_f32_16x16x32_bf16 v[112:115], a[96:99], v[208:211], v[112:115]
    ds_read_b128 a[56:59], v22 offset:8192
    v_exp_f32 v36, v202
    v_mfma_f32_16x16x32_bf16 v[116:119], a[96:99], v[212:215], v[116:119]
    v_cvt_pk_bf16_f32 v228, v40, v41
    v_add_f32 v15, v15, v40
    v_mfma_f32_16x16x32_bf16 v[120:123], a[96:99], v[216:219], v[120:123]
    ds_read_b128 a[60:63], v23 offset:8192
    v_exp_f32 v37, v203
    v_mfma_f32_16x16x32_bf16 v[124:127], a[100:103], v[208:211], v[124:127]
    v_add_f32 v15, v15, v41
    v_exp_f32 v38, v204
    v_mfma_f32_16x16x32_bf16 v[128:131], a[100:103], v[212:215], v[128:131]
    ds_read_b128 a[64:67], v20 offset:12288
    v_cvt_pk_bf16_f32 v229, v36, v37
    v_mfma_f32_16x16x32_bf16 v[132:135], a[100:103], v[216:219], v[132:135]
    v_add_f32 v15, v15, v36
    v_exp_f32 v39, v205
    v_mfma_f32_16x16x32_bf16 v[136:139], a[104:107], v[208:211], v[136:139]
    ds_read_b128 a[68:71], v21 offset:12288
    v_add_f32 v15, v15, v37
    v_mfma_f32_16x16x32_bf16 v[140:143], a[104:107], v[212:215], v[140:143]
    v_exp_f32 v40, v206
    v_mfma_f32_16x16x32_bf16 v[144:147], a[104:107], v[216:219], v[144:147]
    ds_read_b128 a[72:75], v22 offset:12288
    v_cvt_pk_bf16_f32 v230, v38, v39
    v_add_f32 v15, v15, v38
    v_mfma_f32_16x16x32_bf16 v[148:151], a[108:111], v[208:211], v[148:151]
    v_exp_f32 v41, v207
    v_mfma_f32_16x16x32_bf16 v[152:155], a[108:111], v[212:215], v[152:155]
    ds_read_b128 a[76:79], v23 offset:12288
    v_add_f32 v15, v15, v39
    v_add_f32 v15, v15, v40
    v_mfma_f32_16x16x32_bf16 v[156:159], a[108:111], v[216:219], v[156:159]
    v_add_f32 v15, v15, v41
    v_cvt_pk_bf16_f32 v231, v40, v41
    s_waitcnt lgkmcnt(4)
    v_mfma_f32_16x16x32_bf16 v[184:187], a[48:51], a[0:3], v[52:55]
    ds_read_b64_tr_b16 a[80:81], v24 offset:24576
    v_exp_f32 v36, v160
    v_mfma_f32_16x16x32_bf16 v[184:187], a[52:55], a[4:7], v[184:187]
    ds_read_b64_tr_b16 a[82:83], v24 offset:28672
    v_exp_f32 v37, v161
    v_mfma_f32_16x16x32_bf16 v[184:187], a[56:59], a[8:11], v[184:187]
    s_add_u32 m0, s39, 65536
    s_add_u32 s39, s39, 16384
    v_mfma_f32_16x16x32_bf16 v[184:187], a[60:63], a[12:15], v[184:187]
    ds_read_b64_tr_b16 a[84:85], v25 offset:24576
    buffer_load_dwordx4 v6, s[20:23], s37 offen nt lds
    v_mfma_f32_16x16x32_bf16 v[192:195], a[48:51], a[16:19], v[56:59]
    ds_read_b64_tr_b16 a[86:87], v25 offset:28672
    v_exp_f32 v38, v162
    v_mfma_f32_16x16x32_bf16 v[192:195], a[52:55], a[20:23], v[192:195]
    buffer_load_dwordx4 v7, s[20:23], s37 offen offset:1024 nt lds
    v_cvt_pk_bf16_f32 v208, v36, v37
    v_add_f32 v13, v13, v36
    v_mfma_f32_16x16x32_bf16 v[192:195], a[56:59], a[24:27], v[192:195]
    ds_read_b64_tr_b16 a[88:89], v26 offset:24576
    v_exp_f32 v39, v163
    v_mfma_f32_16x16x32_bf16 v[192:195], a[60:63], a[28:31], v[192:195]
    ds_read_b64_tr_b16 a[90:91], v26 offset:28672
    buffer_load_dwordx4 v6, s[20:23], s37 offen offset:2048 nt lds
    v_add_f32 v13, v13, v37
    v_mfma_f32_16x16x32_bf16 v[200:203], a[48:51], a[32:35], v[60:63]
    v_exp_f32 v40, v164
    v_mfma_f32_16x16x32_bf16 v[200:203], a[52:55], a[36:39], v[200:203]
    ds_read_b64_tr_b16 a[92:93], v27 offset:24576
    buffer_load_dwordx4 v7, s[20:23], s37 offen offset:3072 nt lds
    v_cvt_pk_bf16_f32 v209, v38, v39
    v_mfma_f32_16x16x32_bf16 v[200:203], a[56:59], a[40:43], v[200:203]
    ds_read_b64_tr_b16 a[94:95], v27 offset:28672
    s_add_u32 s37, s37, 16384
    s_and_b32 s39, s39, 0xffff
    v_mfma_f32_16x16x32_bf16 v[200:203], a[60:63], a[44:47], v[200:203]
    v_add_f32 v13, v13, v38
    s_waitcnt lgkmcnt(8)
    v_mfma_f32_16x16x32_bf16 v[188:191], a[64:67], a[0:3], v[52:55]
    ds_read_b64_tr_b16 a[96:97], v28 offset:24576
    v_exp_f32 v41, v165
    v_mfma_f32_16x16x32_bf16 v[188:191], a[68:71], a[4:7], v[188:191]
    ds_read_b64_tr_b16 a[98:99], v28 offset:28672
    v_add_f32 v13, v13, v39
    v_mfma_f32_16x16x32_bf16 v[188:191], a[72:75], a[8:11], v[188:191]
    v_exp_f32 v36, v166
    v_cvt_pk_bf16_f32 v210, v40, v41
    v_mfma_f32_16x16x32_bf16 v[188:191], a[76:79], a[12:15], v[188:191]
    ds_read_b64_tr_b16 a[100:101], v29 offset:24576
    v_add_f32 v13, v13, v40
    v_mfma_f32_16x16x32_bf16 v[196:199], a[64:67], a[16:19], v[56:59]
    ds_read_b64_tr_b16 a[102:103], v29 offset:28672
    v_exp_f32 v37, v167
    v_mfma_f32_16x16x32_bf16 v[196:199], a[68:71], a[20:23], v[196:199]
    v_add_f32 v13, v13, v41
    v_exp_f32 v38, v168
    v_mfma_f32_16x16x32_bf16 v[196:199], a[72:75], a[24:27], v[196:199]
    ds_read_b64_tr_b16 a[104:105], v30 offset:24576
    v_cvt_pk_bf16_f32 v211, v36, v37
    v_add_f32 v13, v13, v36
    v_mfma_f32_16x16x32_bf16 v[196:199], a[76:79], a[28:31], v[196:199]
    ds_read_b64_tr_b16 a[106:107], v30 offset:28672
    v_exp_f32 v39, v169
    v_mfma_f32_16x16x32_bf16 v[204:207], a[64:67], a[32:35], v[60:63]
    v_add_f32 v13, v13, v37
    v_exp_f32 v40, v170
    v_mfma_f32_16x16x32_bf16 v[204:207], a[68:71], a[36:39], v[204:207]
    ds_read_b64_tr_b16 a[108:109], v31 offset:24576
    v_cvt_pk_bf16_f32 v212, v38, v39
    v_mfma_f32_16x16x32_bf16 v[204:207], a[72:75], a[40:43], v[204:207]
    ds_read_b64_tr_b16 a[110:111], v31 offset:28672
    v_add_f32 v14, v14, v38
    v_mfma_f32_16x16x32_bf16 v[204:207], a[76:79], a[44:47], v[204:207]
    v_exp_f32 v41, v171
    s_waitcnt lgkmcnt(8)
    v_mfma_f32_16x16x32_bf16 v[64:67], a[80:83], v[220:223], v[64:67]
    v_add_f32 v14, v14, v39
    v_exp_f32 v36, v172
    v_mfma_f32_16x16x32_bf16 v[68:71], a[80:83], v[224:227], v[68:71]
    v_cvt_pk_bf16_f32 v213, v40, v41
    v_add_f32 v14, v14, v40
    v_mfma_f32_16x16x32_bf16 v[72:75], a[80:83], v[228:231], v[72:75]
    v_exp_f32 v37, v173
    v_add_f32 v14, v14, v41
    v_mfma_f32_16x16x32_bf16 v[76:79], a[84:87], v[220:223], v[76:79]
    v_exp_f32 v38, v174
    v_cvt_pk_bf16_f32 v214, v36, v37
    v_mfma_f32_16x16x32_bf16 v[80:83], a[84:87], v[224:227], v[80:83]
    v_add_f32 v14, v14, v36
    v_exp_f32 v39, v175
    v_mfma_f32_16x16x32_bf16 v[84:87], a[84:87], v[228:231], v[84:87]
    v_add_f32 v14, v14, v37
    v_exp_f32 v40, v176
    v_mfma_f32_16x16x32_bf16 v[88:91], a[88:91], v[220:223], v[88:91]
    v_cvt_pk_bf16_f32 v215, v38, v39
    v_add_f32 v14, v14, v38
    v_mfma_f32_16x16x32_bf16 v[92:95], a[88:91], v[224:227], v[92:95]
    v_xor_b32 v24, 0x8000, v24
    v_xor_b32 v25, 0x8000, v25
    v_xor_b32 v26, 0x8000, v26
    v_mfma_f32_16x16x32_bf16 v[96:99], a[88:91], v[228:231], v[96:99]
    v_xor_b32 v27, 0x8000, v27
    v_xor_b32 v28, 0x8000, v28
    v_xor_b32 v29, 0x8000, v29
    v_mfma_f32_16x16x32_bf16 v[100:103], a[92:95], v[220:223], v[100:103]
    v_xor_b32 v30, 0x8000, v30
    v_xor_b32 v31, 0x8000, v31
    v_mfma_f32_16x16x32_bf16 v[104:107], a[92:95], v[224:227], v[104:107]
    s_waitcnt vmcnt(8) lgkmcnt(0)
    s_barrier
    ds_read_b128 a[48:51], v20 offset:16384
    v_mfma_f32_16x16x32_bf16 v[108:111], a[92:95], v[228:231], v[108:111]
    ds_read_b128 a[52:55], v21 offset:16384
    v_mfma_f32_16x16x32_bf16 v[112:115], a[96:99], v[220:223], v[112:115]
    ds_read_b128 a[56:59], v22 offset:16384
    v_exp_f32 v41, v177
    v_mfma_f32_16x16x32_bf16 v[116:119], a[96:99], v[224:227], v[116:119]
    v_add_f32 v14, v14, v39
    v_exp_f32 v36, v178
    v_mfma_f32_16x16x32_bf16 v[120:123], a[96:99], v[228:231], v[120:123]
    ds_read_b128 a[60:63], v23 offset:16384
    v_cvt_pk_bf16_f32 v216, v40, v41
    v_add_f32 v15, v15, v40
    v_mfma_f32_16x16x32_bf16 v[124:127], a[100:103], v[220:223], v[124:127]
    v_exp_f32 v37, v179
    v_add_f32 v15, v15, v41
    v_mfma_f32_16x16x32_bf16 v[128:131], a[100:103], v[224:227], v[128:131]
    ds_read_b128 a[64:67], v20 offset:20480
    v_exp_f32 v38, v180
    v_mfma_f32_16x16x32_bf16 v[132:135], a[100:103], v[228:231], v[132:135]
    v_cvt_pk_bf16_f32 v217, v36, v37
    v_add_f32 v15, v15, v36
    v_mfma_f32_16x16x32_bf16 v[136:139], a[104:107], v[220:223], v[136:139]
    ds_read_b128 a[68:71], v21 offset:20480
    v_exp_f32 v39, v181
    v_mfma_f32_16x16x32_bf16 v[140:143], a[104:107], v[224:227], v[140:143]
    v_add_f32 v15, v15, v37
    v_exp_f32 v40, v182
    v_mfma_f32_16x16x32_bf16 v[144:147], a[104:107], v[228:231], v[144:147]
    ds_read_b128 a[72:75], v22 offset:20480
    v_cvt_pk_bf16_f32 v218, v38, v39
    v_mfma_f32_16x16x32_bf16 v[148:151], a[108:111], v[220:223], v[148:151]
    v_add_f32 v15, v15, v38
    v_exp_f32 v41, v183
    v_mfma_f32_16x16x32_bf16 v[152:155], a[108:111], v[224:227], v[152:155]
    ds_read_b128 a[76:79], v23 offset:20480
    v_add_f32 v15, v15, v39
    v_mfma_f32_16x16x32_bf16 v[156:159], a[108:111], v[228:231], v[156:159]
    v_add_f32 v15, v15, v40
    v_add_f32 v15, v15, v41
    v_cvt_pk_bf16_f32 v219, v40, v41
    s_waitcnt lgkmcnt(4)
    v_mfma_f32_16x16x32_bf16 v[160:163], a[48:51], a[0:3], v[52:55]
    ds_read_b64_tr_b16 a[80:81], v24
    v_exp_f32 v36, v184
    v_mfma_f32_16x16x32_bf16 v[160:163], a[52:55], a[4:7], v[160:163]
    ds_read_b64_tr_b16 a[82:83], v24 offset:4096
    v_mfma_f32_16x16x32_bf16 v[160:163], a[56:59], a[8:11], v[160:163]
    s_mov_b32 m0, s38
    s_add_u32 s38, s38, 16384
    v_mfma_f32_16x16x32_bf16 v[160:163], a[60:63], a[12:15], v[160:163]
    ds_read_b64_tr_b16 a[84:85], v25
    buffer_load_dwordx4 v2, s[16:19], s36 offen nt lds
    v_mfma_f32_16x16x32_bf16 v[168:171], a[48:51], a[16:19], v[56:59]
    ds_read_b64_tr_b16 a[86:87], v25 offset:4096
    v_exp_f32 v37, v185
    v_mfma_f32_16x16x32_bf16 v[168:171], a[52:55], a[20:23], v[168:171]
    buffer_load_dwordx4 v3, s[16:19], s36 offen offset:1024 nt lds
    v_exp_f32 v38, v186
    v_mfma_f32_16x16x32_bf16 v[168:171], a[56:59], a[24:27], v[168:171]
    ds_read_b64_tr_b16 a[88:89], v26
    v_cvt_pk_bf16_f32 v220, v36, v37
    v_add_f32 v13, v13, v36
    v_mfma_f32_16x16x32_bf16 v[168:171], a[60:63], a[28:31], v[168:171]
    ds_read_b64_tr_b16 a[90:91], v26 offset:4096
    buffer_load_dwordx4 v4, s[16:19], s36 offen offset:2048 nt lds
    v_mfma_f32_16x16x32_bf16 v[176:179], a[48:51], a[32:35], v[60:63]
    v_exp_f32 v39, v187
    v_add_f32 v13, v13, v37
    v_mfma_f32_16x16x32_bf16 v[176:179], a[52:55], a[36:39], v[176:179]
    ds_read_b64_tr_b16 a[92:93], v27
    buffer_load_dwordx4 v5, s[16:19], s36 offen offset:3072 nt lds
    v_mfma_f32_16x16x32_bf16 v[176:179], a[56:59], a[40:43], v[176:179]
    ds_read_b64_tr_b16 a[94:95], v27 offset:4096
    s_add_u32 s36, s36, 16384
    s_and_b32 s38, s38, 0xffff
    v_mfma_f32_16x16x32_bf16 v[176:179], a[60:63], a[44:47], v[176:179]
    v_exp_f32 v40, v188
    s_waitcnt lgkmcnt(8)
    v_mfma_f32_16x16x32_bf16 v[164:167], a[64:67], a[0:3], v[52:55]
    ds_read_b64_tr_b16 a[96:97], v28
    v_cvt_pk_bf16_f32 v221, v38, v39
    v_mfma_f32_16x16x32_bf16 v[164:167], a[68:71], a[4:7], v[164:167]
    ds_read_b64_tr_b16 a[98:99], v28 offset:4096
    v_add_f32 v13, v13, v38
    v_mfma_f32_16x16x32_bf16 v[164:167], a[72:75], a[8:11], v[164:167]
    v_exp_f32 v41, v189
    v_add_f32 v13, v13, v39
    v_mfma_f32_16x16x32_bf16 v[164:167], a[76:79], a[12:15], v[164:167]
    ds_read_b64_tr_b16 a[100:101], v29
    v_exp_f32 v36, v190
    v_mfma_f32_16x16x32_bf16 v[172:175], a[64:67], a[16:19], v[56:59]
    ds_read_b64_tr_b16 a[102:103], v29 offset:4096
    v_cvt_pk_bf16_f32 v222, v40, v41
    v_mfma_f32_16x16x32_bf16 v[172:175], a[68:71], a[20:23], v[172:175]
    v_add_f32 v13, v13, v40
    v_exp_f32 v37, v191
    v_mfma_f32_16x16x32_bf16 v[172:175], a[72:75], a[24:27], v[172:175]
    ds_read_b64_tr_b16 a[104:105], v30
    v_add_f32 v13, v13, v41
    v_mfma_f32_16x16x32_bf16 v[172:175], a[76:79], a[28:31], v[172:175]
    ds_read_b64_tr_b16 a[106:107], v30 offset:4096
    v_exp_f32 v38, v192
    v_mfma_f32_16x16x32_bf16 v[180:183], a[64:67], a[32:35], v[60:63]
    v_cvt_pk_bf16_f32 v223, v36, v37
    v_add_f32 v13, v13, v36
    v_mfma_f32_16x16x32_bf16 v[180:183], a[68:71], a[36:39], v[180:183]
    ds_read_b64_tr_b16 a[108:109], v31
    v_exp_f32 v39, v193
    v_mfma_f32_16x16x32_bf16 v[180:183], a[72:75], a[40:43], v[180:183]
    ds_read_b64_tr_b16 a[110:111], v31 offset:4096
    v_add_f32 v13, v13, v37
    v_mfma_f32_16x16x32_bf16 v[180:183], a[76:79], a[44:47], v[180:183]
    v_exp_f32 v40, v194
    s_waitcnt lgkmcnt(8)
    v_mfma_f32_16x16x32_bf16 v[64:67], a[80:83], v[208:211], v[64:67]
    v_cvt_pk_bf16_f32 v224, v38, v39
    v_add_f32 v14, v14, v38
    v_mfma_f32_16x16x32_bf16 v[68:71], a[80:83], v[212:215], v[68:71]
    v_exp_f32 v41, v195
    v_mfma_f32_16x16x32_bf16 v[72:75], a[80:83], v[216:219], v[72:75]
    v_add_f32 v14, v14, v39
    v_exp_f32 v36, v196
    v_mfma_f32_16x16x32_bf16 v[76:79], a[84:87], v[208:211], v[76:79]
    v_cvt_pk_bf16_f32 v225, v40, v41
    v_add_f32 v14, v14, v40
    v_mfma_f32_16x16x32_bf16 v[80:83], a[84:87], v[212:215], v[80:83]
    v_exp_f32 v37, v197
    v_add_f32 v14, v14, v41
    v_mfma_f32_16x16x32_bf16 v[84:87], a[84:87], v[216:219], v[84:87]
    v_exp_f32 v38, v198
    v_mfma_f32_16x16x32_bf16 v[88:91], a[88:91], v[208:211], v[88:91]
    v_cvt_pk_bf16_f32 v226, v36, v37
    v_add_f32 v14, v14, v36
    v_mfma_f32_16x16x32_bf16 v[92:95], a[88:91], v[212:215], v[92:95]
    v_exp_f32 v39, v199
    v_add_f32 v14, v14, v37
    v_mfma_f32_16x16x32_bf16 v[96:99], a[88:91], v[216:219], v[96:99]
    v_exp_f32 v40, v200
    v_cvt_pk_bf16_f32 v227, v38, v39
    v_mfma_f32_16x16x32_bf16 v[100:103], a[92:95], v[208:211], v[100:103]
    v_add_f32 v14, v14, v38
    v_exp_f32 v41, v201
    v_mfma_f32_16x16x32_bf16 v[104:107], a[92:95], v[212:215], v[104:107]
    ds_read_b128 a[48:51], v20 offset:24576
    v_add_f32 v14, v14, v39
    v_mfma_f32_16x16x32_bf16 v[108:111], a[92:95], v[216:219], v[108:111]
    ds_read_b128 a[52:55], v21 offset:24576
    s_waitcnt lgkmcnt(2)
    v_mfma_f32_16x16x32_bf16 v[112:115], a[96:99], v[208:211], v[112:115]
    ds_read_b128 a[56:59], v22 offset:24576
    v_exp_f32 v36, v202
    v_mfma_f32_16x16x32_bf16 v[116:119], a[96:99], v[212:215], v[116:119]
    v_cvt_pk_bf16_f32 v228, v40, v41
    v_add_f32 v15, v15, v40
    v_mfma_f32_16x16x32_bf16 v[120:123], a[96:99], v[216:219], v[120:123]
    ds_read_b128 a[60:63], v23 offset:24576
    v_exp_f32 v37, v203
    v_mfma_f32_16x16x32_bf16 v[124:127], a[100:103], v[208:211], v[124:127]
    v_add_f32 v15, v15, v41
    v_exp_f32 v38, v204
    v_mfma_f32_16x16x32_bf16 v[128:131], a[100:103], v[212:215], v[128:131]
    ds_read_b128 a[64:67], v20 offset:28672
    v_cvt_pk_bf16_f32 v229, v36, v37
    v_mfma_f32_16x16x32_bf16 v[132:135], a[100:103], v[216:219], v[132:135]
    v_add_f32 v15, v15, v36
    v_exp_f32 v39, v205
    v_mfma_f32_16x16x32_bf16 v[136:139], a[104:107], v[208:211], v[136:139]
    ds_read_b128 a[68:71], v21 offset:28672
    v_add_f32 v15, v15, v37
    v_mfma_f32_16x16x32_bf16 v[140:143], a[104:107], v[212:215], v[140:143]
    v_exp_f32 v40, v206
    v_mfma_f32_16x16x32_bf16 v[144:147], a[104:107], v[216:219], v[144:147]
    ds_read_b128 a[72:75], v22 offset:28672
    v_cvt_pk_bf16_f32 v230, v38, v39
    v_add_f32 v15, v15, v38
    v_mfma_f32_16x16x32_bf16 v[148:151], a[108:111], v[208:211], v[148:151]
    v_exp_f32 v41, v207
    v_mfma_f32_16x16x32_bf16 v[152:155], a[108:111], v[212:215], v[152:155]
    ds_read_b128 a[76:79], v23 offset:28672
    v_add_f32 v15, v15, v39
    v_add_f32 v15, v15, v40
    v_mfma_f32_16x16x32_bf16 v[156:159], a[108:111], v[216:219], v[156:159]
    v_add_f32 v15, v15, v41
    v_cvt_pk_bf16_f32 v231, v40, v41
    s_add_u32 s29, s29, 2
    s_waitcnt lgkmcnt(4)
    v_mfma_f32_16x16x32_bf16 v[184:187], a[48:51], a[0:3], v[52:55]
    ds_read_b64_tr_b16 a[80:81], v24 offset:8192
    v_xor_b32 v20, 0x8000, v20
    v_xor_b32 v21, 0x8000, v21
    v_mfma_f32_16x16x32_bf16 v[184:187], a[52:55], a[4:7], v[184:187]
    ds_read_b64_tr_b16 a[82:83], v24 offset:12288
    v_xor_b32 v22, 0x8000, v22
    v_mfma_f32_16x16x32_bf16 v[184:187], a[56:59], a[8:11], v[184:187]
    s_add_u32 m0, s39, 65536
    s_add_u32 s39, s39, 16384
    v_xor_b32 v23, 0x8000, v23
    v_mfma_f32_16x16x32_bf16 v[184:187], a[60:63], a[12:15], v[184:187]
    ds_read_b64_tr_b16 a[84:85], v25 offset:8192
    buffer_load_dwordx4 v6, s[20:23], s37 offen nt lds
    v_mfma_f32_16x16x32_bf16 v[192:195], a[48:51], a[16:19], v[56:59]
    ds_read_b64_tr_b16 a[86:87], v25 offset:12288
    v_exp_f32 v36, v160
    v_mfma_f32_16x16x32_bf16 v[192:195], a[52:55], a[20:23], v[192:195]
    buffer_load_dwordx4 v7, s[20:23], s37 offen offset:1024 nt lds
    v_exp_f32 v37, v161
    v_mfma_f32_16x16x32_bf16 v[192:195], a[56:59], a[24:27], v[192:195]
    ds_read_b64_tr_b16 a[88:89], v26 offset:8192
    v_exp_f32 v38, v162
    v_mfma_f32_16x16x32_bf16 v[192:195], a[60:63], a[28:31], v[192:195]
    ds_read_b64_tr_b16 a[90:91], v26 offset:12288
    buffer_load_dwordx4 v6, s[20:23], s37 offen offset:2048 nt lds
    v_mfma_f32_16x16x32_bf16 v[200:203], a[48:51], a[32:35], v[60:63]
    v_cvt_pk_bf16_f32 v208, v36, v37
    v_add_f32 v13, v13, v36
    v_mfma_f32_16x16x32_bf16 v[200:203], a[52:55], a[36:39], v[200:203]
    ds_read_b64_tr_b16 a[92:93], v27 offset:8192
    buffer_load_dwordx4 v7, s[20:23], s37 offen offset:3072 nt lds
    v_mfma_f32_16x16x32_bf16 v[200:203], a[56:59], a[40:43], v[200:203]
    ds_read_b64_tr_b16 a[94:95], v27 offset:12288
    s_add_u32 s37, s37, 16384
    s_and_b32 s39, s39, 0xffff
    v_mfma_f32_16x16x32_bf16 v[200:203], a[60:63], a[44:47], v[200:203]
    v_exp_f32 v39, v163
    s_waitcnt lgkmcnt(8)
    v_mfma_f32_16x16x32_bf16 v[188:191], a[64:67], a[0:3], v[52:55]
    ds_read_b64_tr_b16 a[96:97], v28 offset:8192
    v_add_f32 v13, v13, v37
    v_mfma_f32_16x16x32_bf16 v[188:191], a[68:71], a[4:7], v[188:191]
    ds_read_b64_tr_b16 a[98:99], v28 offset:12288
    v_exp_f32 v40, v164
    v_mfma_f32_16x16x32_bf16 v[188:191], a[72:75], a[8:11], v[188:191]
    v_cvt_pk_bf16_f32 v209, v38, v39
    v_add_f32 v13, v13, v38
    v_mfma_f32_16x16x32_bf16 v[188:191], a[76:79], a[12:15], v[188:191]
    ds_read_b64_tr_b16 a[100:101], v29 offset:8192
    v_exp_f32 v41, v165
    v_mfma_f32_16x16x32_bf16 v[196:199], a[64:67], a[16:19], v[56:59]
    ds_read_b64_tr_b16 a[102:103], v29 offset:12288
    v_add_f32 v13, v13, v39
    v_mfma_f32_16x16x32_bf16 v[196:199], a[68:71], a[20:23], v[196:199]
    v_exp_f32 v36, v166
    v_cvt_pk_bf16_f32 v210, v40, v41
    v_mfma_f32_16x16x32_bf16 v[196:199], a[72:75], a[24:27], v[196:199]
    ds_read_b64_tr_b16 a[104:105], v30 offset:8192
    v_add_f32 v13, v13, v40
    v_mfma_f32_16x16x32_bf16 v[196:199], a[76:79], a[28:31], v[196:199]
    ds_read_b64_tr_b16 a[106:107], v30 offset:12288
    v_exp_f32 v37, v167
    v_add_f32 v13, v13, v41
    v_mfma_f32_16x16x32_bf16 v[204:207], a[64:67], a[32:35], v[60:63]
    v_exp_f32 v38, v168
    v_cvt_pk_bf16_f32 v211, v36, v37
    v_mfma_f32_16x16x32_bf16 v[204:207], a[68:71], a[36:39], v[204:207]
    ds_read_b64_tr_b16 a[108:109], v31 offset:8192
    v_add_f32 v13, v13, v36
    v_mfma_f32_16x16x32_bf16 v[204:207], a[72:75], a[40:43], v[204:207]
    ds_read_b64_tr_b16 a[110:111], v31 offset:12288
    v_exp_f32 v39, v169
    v_mfma_f32_16x16x32_bf16 v[204:207], a[76:79], a[44:47], v[204:207]
    v_add_f32 v13, v13, v37
    s_waitcnt lgkmcnt(8)
    v_mfma_f32_16x16x32_bf16 v[64:67], a[80:83], v[220:223], v[64:67]
    v_exp_f32 v40, v170
    v_cvt_pk_bf16_f32 v212, v38, v39
    v_mfma_f32_16x16x32_bf16 v[68:71], a[80:83], v[224:227], v[68:71]
    v_add_f32 v14, v14, v38
    v_exp_f32 v41, v171
    v_mfma_f32_16x16x32_bf16 v[72:75], a[80:83], v[228:231], v[72:75]
    v_add_f32 v14, v14, v39
    v_exp_f32 v36, v172
    v_mfma_f32_16x16x32_bf16 v[76:79], a[84:87], v[220:223], v[76:79]
    v_cvt_pk_bf16_f32 v213, v40, v41
    v_add_f32 v14, v14, v40
    v_mfma_f32_16x16x32_bf16 v[80:83], a[84:87], v[224:227], v[80:83]
    v_exp_f32 v37, v173
    v_add_f32 v14, v14, v41
    v_mfma_f32_16x16x32_bf16 v[84:87], a[84:87], v[228:231], v[84:87]
    v_exp_f32 v38, v174
    v_mfma_f32_16x16x32_bf16 v[88:91], a[88:91], v[220:223], v[88:91]
    v_cvt_pk_bf16_f32 v214, v36, v37
    v_add_f32 v14, v14, v36
    v_mfma_f32_16x16x32_bf16 v[92:95], a[88:91], v[224:227], v[92:95]
    v_exp_f32 v39, v175
    v_add_f32 v14, v14, v37
    v_mfma_f32_16x16x32_bf16 v[96:99], a[88:91], v[228:231], v[96:99]
    v_exp_f32 v40, v176
    v_cvt_pk_bf16_f32 v215, v38, v39
    v_mfma_f32_16x16x32_bf16 v[100:103], a[92:95], v[220:223], v[100:103]
    v_add_f32 v14, v14, v38
    v_exp_f32 v41, v177
    v_mfma_f32_16x16x32_bf16 v[104:107], a[92:95], v[224:227], v[104:107]
    s_waitcnt vmcnt(8) lgkmcnt(0)
    s_barrier
    ds_read_b128 a[48:51], v20
    v_mfma_f32_16x16x32_bf16 v[108:111], a[92:95], v[228:231], v[108:111]
    ds_read_b128 a[52:55], v21
    v_mfma_f32_16x16x32_bf16 v[112:115], a[96:99], v[220:223], v[112:115]
    ds_read_b128 a[56:59], v22
    v_add_f32 v14, v14, v39
    v_mfma_f32_16x16x32_bf16 v[116:119], a[96:99], v[224:227], v[116:119]
    v_exp_f32 v36, v178
    v_cvt_pk_bf16_f32 v216, v40, v41
    v_mfma_f32_16x16x32_bf16 v[120:123], a[96:99], v[228:231], v[120:123]
    ds_read_b128 a[60:63], v23
    v_add_f32 v15, v15, v40
    v_mfma_f32_16x16x32_bf16 v[124:127], a[100:103], v[220:223], v[124:127]
    v_exp_f32 v37, v179
    v_add_f32 v15, v15, v41
    v_mfma_f32_16x16x32_bf16 v[128:131], a[100:103], v[224:227], v[128:131]
    ds_read_b128 a[64:67], v20 offset:4096
    v_exp_f32 v38, v180
    v_mfma_f32_16x16x32_bf16 v[132:135], a[100:103], v[228:231], v[132:135]
    v_cvt_pk_bf16_f32 v217, v36, v37
    v_add_f32 v15, v15, v36
    v_mfma_f32_16x16x32_bf16 v[136:139], a[104:107], v[220:223], v[136:139]
    ds_read_b128 a[68:71], v21 offset:4096
    v_exp_f32 v39, v181
    v_mfma_f32_16x16x32_bf16 v[140:143], a[104:107], v[224:227], v[140:143]
    v_add_f32 v15, v15, v37
    v_exp_f32 v40, v182
    v_mfma_f32_16x16x32_bf16 v[144:147], a[104:107], v[228:231], v[144:147]
    ds_read_b128 a[72:75], v22 offset:4096
    v_cvt_pk_bf16_f32 v218, v38, v39
    v_mfma_f32_16x16x32_bf16 v[148:151], a[108:111], v[220:223], v[148:151]
    v_add_f32 v15, v15, v38
    v_exp_f32 v41, v183
    v_mfma_f32_16x16x32_bf16 v[152:155], a[108:111], v[224:227], v[152:155]
    ds_read_b128 a[76:79], v23 offset:4096
    v_add_f32 v15, v15, v39
    v_mfma_f32_16x16x32_bf16 v[156:159], a[108:111], v[228:231], v[156:159]
    v_add_f32 v15, v15, v40
    v_add_f32 v15, v15, v41
    v_cvt_pk_bf16_f32 v219, v40, v41
    s_cmp_lt_u32 s29, 16
    s_cbranch_scc1 L_loop
L_tail:
L_tail2:
    ds_read_b64_tr_b16 a[80:81], v24 offset:16384
    ds_read_b64_tr_b16 a[82:83], v24 offset:20480
    ds_read_b64_tr_b16 a[84:85], v25 offset:16384
    ds_read_b64_tr_b16 a[86:87], v25 offset:20480
    ds_read_b64_tr_b16 a[88:89], v26 offset:16384
    ds_read_b64_tr_b16 a[90:91], v26 offset:20480
    ds_read_b64_tr_b16 a[92:93], v27 offset:16384
    ds_read_b64_tr_b16 a[94:95], v27 offset:20480
    ds_read_b64_tr_b16 a[96:97], v28 offset:16384
    ds_read_b64_tr_b16 a[98:99], v28 offset:20480
    ds_read_b64_tr_b16 a[100:101], v29 offset:16384
    ds_read_b64_tr_b16 a[102:103], v29 offset:20480
    ds_read_b64_tr_b16 a[104:105], v30 offset:16384
    ds_read_b64_tr_b16 a[106:107], v30 offset:20480
    ds_read_b64_tr_b16 a[108:109], v31 offset:16384
    ds_read_b64_tr_b16 a[110:111], v31 offset:20480
    v_max3_f32 v32, v13, v14, v15
    v_cmp_nge_f32 vcc, 0x5d800000, v32
    s_lshl_b32 s40, s28, 2
    s_add_u32 s40, s40, 159744
    v_mov_b32 v34, s40
    s_or_b32 s41, vcc_lo, vcc_hi
    v_mov_b32 v35, 159744
    v_mov_b32 v33, s41
    ds_write_b32 v34, v33
    v_add_u32 v20, s44, v243
    v_xor_b32 v21, 64, v20
    v_xor_b32 v22, 128, v20
    v_xor_b32 v23, 192, v20
    v_add_u32 v2, s44, v2
    v_add_u32 v3, s44, v3
    v_add_u32 v4, s44, v4
    v_add_u32 v5, s44, v5
    v_exp_f32 v36, v184
    v_exp_f32 v37, v185
    v_exp_f32 v38, v186
    s_waitcnt lgkmcnt(9)
    v_mfma_f32_16x16x32_bf16 v[64:67], a[80:83], v[208:211], v[64:67]
    ds_read_b64_tr_b16 a[48:49], v24 offset:24576
    ds_read_b64_tr_b16 a[50:51], v24 offset:28672
    v_cvt_pk_bf16_f32 v220, v36, v37
    v_add_f32 v16, v36, v37
    v_mfma_f32_16x16x32_bf16 v[76:79], a[84:87], v[208:211], v[76:79]
    ds_read_b64_tr_b16 a[52:53], v25 offset:24576
    ds_read_b64_tr_b16 a[54:55], v25 offset:28672
    v_exp_f32 v39, v187
    v_exp_f32 v40, v188
    v_cvt_pk_bf16_f32 v221, v38, v39
    v_mfma_f32_16x16x32_bf16 v[88:91], a[88:91], v[208:211], v[88:91]
    ds_read_b64_tr_b16 a[56:57], v26 offset:24576
    ds_read_b64_tr_b16 a[58:59], v26 offset:28672
    v_add_f32 v16, v16, v38
    v_exp_f32 v41, v189
    v_mfma_f32_16x16x32_bf16 v[100:103], a[92:95], v[208:211], v[100:103]
    ds_read_b64_tr_b16 a[60:61], v27 offset:24576
    ds_read_b64_tr_b16 a[62:63], v27 offset:28672
    v_add_f32 v16, v16, v39
    v_exp_f32 v36, v190
    s_waitcnt lgkmcnt(9)
    v_mfma_f32_16x16x32_bf16 v[112:115], a[96:99], v[208:211], v[112:115]
    ds_read_b64_tr_b16 a[64:65], v28 offset:24576
    ds_read_b64_tr_b16 a[66:67], v28 offset:28672
    v_cvt_pk_bf16_f32 v222, v40, v41
    v_add_f32 v16, v16, v40
    v_mfma_f32_16x16x32_bf16 v[124:127], a[100:103], v[208:211], v[124:127]
    ds_read_b64_tr_b16 a[68:69], v29 offset:24576
    ds_read_b64_tr_b16 a[70:71], v29 offset:28672
    v_exp_f32 v37, v191
    v_add_f32 v16, v16, v41
    v_add_f32 v16, v16, v36
    v_add_f32 v16, v16, v37
    v_mfma_f32_16x16x32_bf16 v[136:139], a[104:107], v[208:211], v[136:139]
    ds_read_b64_tr_b16 a[72:73], v30 offset:24576
    ds_read_b64_tr_b16 a[74:75], v30 offset:28672
    v_cvt_pk_bf16_f32 v223, v36, v37
    v_cmp_nge_f32 vcc, 0x45800000, v16
    v_mfma_f32_16x16x32_bf16 v[148:151], a[108:111], v[208:211], v[148:151]
    ds_read_b64_tr_b16 a[76:77], v31 offset:24576
    ds_read_b64_tr_b16 a[78:79], v31 offset:28672
    s_cbranch_vccnz L_rare4
L_ret4:
    s_waitcnt lgkmcnt(0)
    s_barrier
    ds_read_b128 v[252:255], v35
    v_mfma_f32_16x16x32_bf16 v[68:71], a[80:83], v[212:215], v[68:71]
    v_add_f32 v13, v13, v16
    v_exp_f32 v36, v192
    v_mfma_f32_16x16x32_bf16 v[80:83], a[84:87], v[212:215], v[80:83]
    v_exp_f32 v37, v193
    v_mfma_f32_16x16x32_bf16 v[92:95], a[88:91], v[212:215], v[92:95]
    v_exp_f32 v38, v194
    v_cvt_pk_bf16_f32 v224, v36, v37
    v_mfma_f32_16x16x32_bf16 v[104:107], a[92:95], v[212:215], v[104:107]
    v_mov_b32 v32, v13
    v_add_f32 v17, v36, v37
    v_mfma_f32_16x16x32_bf16 v[116:119], a[96:99], v[212:215], v[116:119]
    v_exp_f32 v39, v195
    v_permlane16_swap_b32 v13, v32
    v_mfma_f32_16x16x32_bf16 v[128:131], a[100:103], v[212:215], v[128:131]
    v_exp_f32 v40, v196
    v_add_f32 v13, v13, v32
    v_mfma_f32_16x16x32_bf16 v[140:143], a[104:107], v[212:215], v[140:143]
    v_mov_b32 v32, v13
    v_cvt_pk_bf16_f32 v225, v38, v39
    v_mfma_f32_16x16x32_bf16 v[152:155], a[108:111], v[212:215], v[152:155]
    v_add_f32 v17, v17, v38
    v_permlane32_swap_b32 v13, v32
    v_mfma_f32_16x16x32_bf16 v[64:67], a[48:51], v[220:223], v[64:67]
    v_exp_f32 v41, v197
    v_mfma_f32_16x16x32_bf16 v[76:79], a[52:55], v[220:223], v[76:79]
    v_add_f32 v13, v13, v32
    v_rcp_f32 v232, v13
    v_mfma_f32_16x16x32_bf16 v[88:91], a[56:59], v[220:223], v[88:91]
    v_add_f32 v17, v17, v39
    v_exp_f32 v36, v198
    v_mfma_f32_16x16x32_bf16 v[100:103], a[60:63], v[220:223], v[100:103]
    v_cvt_pk_bf16_f32 v226, v40, v41
    v_mfma_f32_16x16x32_bf16 v[112:115], a[64:67], v[220:223], v[112:115]
    v_add_f32 v17, v17, v40
    v_exp_f32 v37, v199
    v_mfma_f32_16x16x32_bf16 v[124:127], a[68:71], v[220:223], v[124:127]
    v_add_f32 v17, v17, v41
    v_add_f32 v17, v17, v36
    v_mfma_f32_16x16x32_bf16 v[136:139], a[72:75], v[220:223], v[136:139]
    v_add_f32 v17, v17, v37
    v_cvt_pk_bf16_f32 v227, v36, v37
    v_cmp_nge_f32 vcc, 0x45800000, v17
    v_mfma_f32_16x16x32_bf16 v[148:151], a[76:79], v[220:223], v[148:151]
    s_cbranch_vccnz L_rare5
L_ret5:
    s_waitcnt lgkmcnt(0)
    v_or3_b32 v252, v252, v253, v254
    v_or_b32 v252, v252, v255
    v_cmp_ne_u32 vcc, 0, v252
    s_cbranch_vccnz L_safe
    v_mfma_f32_16x16x32_bf16 v[72:75], a[80:83], v[216:219], v[72:75]
    v_add_f32 v14, v14, v17
    v_exp_f32 v36, v200
    v_exp_f32 v37, v201
    v_mfma_f32_16x16x32_bf16 v[84:87], a[84:87], v[216:219], v[84:87]
    v_exp_f32 v38, v202
    v_cvt_pk_bf16_f32 v228, v36, v37
    v_mov_b32 v33, v14
    v_add_f32 v18, v36, v37
    v_mfma_f32_16x16x32_bf16 v[96:99], a[88:91], v[216:219], v[96:99]
    v_exp_f32 v39, v203
    v_permlane16_swap_b32 v14, v33
    v_exp_f32 v40, v204
    v_mfma_f32_16x16x32_bf16 v[108:111], a[92:95], v[216:219], v[108:111]
    v_add_f32 v14, v14, v33
    v_mov_b32 v33, v14
    v_cvt_pk_bf16_f32 v229, v38, v39
    v_add_f32 v18, v18, v38
    v_permlane32_swap_b32 v14, v33
    v_mfma_f32_16x16x32_bf16 v[120:123], a[96:99], v[216:219], v[120:123]
    v_exp_f32 v41, v205
    v_add_f32 v14, v14, v33
    v_rcp_f32 v234, v14
    v_add_f32 v18, v18, v39
    v_mfma_f32_16x16x32_bf16 v[132:135], a[100:103], v[216:219], v[132:135]
    v_exp_f32 v36, v206
    v_cvt_pk_bf16_f32 v230, v40, v41
    v_add_f32 v18, v18, v40
    v_mfma_f32_16x16x32_bf16 v[144:147], a[104:107], v[216:219], v[144:147]
    v_exp_f32 v37, v207
    v_add_f32 v18, v18, v41
    v_add_f32 v18, v18, v36
    v_add_f32 v18, v18, v37
    v_cvt_pk_bf16_f32 v231, v36, v37
    v_cmp_nge_f32 vcc, 0x45800000, v18
    v_mfma_f32_16x16x32_bf16 v[156:159], a[108:111], v[216:219], v[156:159]
    s_cbranch_vccnz L_rare6
L_ret6:
    v_mfma_f32_16x16x32_bf16 v[68:71], a[48:51], v[224:227], v[68:71]
    v_add_f32 v15, v15, v18
    v_mul_f32 v64, v232, v64
    v_mul_f32 v65, v232, v65
    v_mov_b32 v34, v15
    v_mfma_f32_16x16x32_bf16 v[80:83], a[52:55], v[224:227], v[80:83]
    v_mul_f32 v66, v232, v66
    v_mul_f32 v67, v232, v67
    v_permlane16_swap_b32 v15, v34
    v_mul_f32 v76, v232, v76
    v_add_f32 v15, v15, v34
    v_mfma_f32_16x16x32_bf16 v[92:95], a[56:59], v[224:227], v[92:95]
    v_mov_b32 v34, v15
    v_mul_f32 v77, v232, v77
    v_mul_f32 v78, v232, v78
    v_permlane32_swap_b32 v15, v34
    v_mul_f32 v79, v232, v79
    v_mfma_f32_16x16x32_bf16 v[104:107], a[60:63], v[224:227], v[104:107]
    v_add_f32 v15, v15, v34
    v_rcp_f32 v244, v15
    v_cvt_pk_bf16_f32 v160, v64, v65
    v_cvt_pk_bf16_f32 v161, v66, v67
    v_mfma_f32_16x16x32_bf16 v[116:119], a[64:67], v[224:227], v[116:119]
    v_cvt_pk_bf16_f32 v162, v76, v77
    v_cvt_pk_bf16_f32 v163, v78, v79
    v_mul_f32 v88, v232, v88
    v_mul_f32 v89, v232, v89
    v_permlane16_swap_b32 v160, v162
    v_mfma_f32_16x16x32_bf16 v[128:131], a[68:71], v[224:227], v[128:131]
    v_permlane16_swap_b32 v161, v163
    v_mul_f32 v90, v232, v90
    ds_write_b128 v20, v[160:163] offset:0
    v_mul_f32 v91, v232, v91
    v_mfma_f32_16x16x32_bf16 v[140:143], a[72:75], v[224:227], v[140:143]
    v_mul_f32 v100, v232, v100
    v_mul_f32 v101, v232, v101
    v_mul_f32 v102, v232, v102
    v_mul_f32 v103, v232, v103
    v_cvt_pk_bf16_f32 v164, v88, v89
    v_mfma_f32_16x16x32_bf16 v[152:155], a[76:79], v[224:227], v[152:155]
    v_cvt_pk_bf16_f32 v165, v90, v91
    v_cvt_pk_bf16_f32 v166, v100, v101
    v_cvt_pk_bf16_f32 v167, v102, v103
    v_mul_f32 v112, v232, v112
    v_mul_f32 v113, v232, v113
    v_mfma_f32_16x16x32_bf16 v[72:75], a[48:51], v[228:231], v[72:75]
    v_permlane16_swap_b32 v164, v166
    v_permlane16_swap_b32 v165, v167
    v_mul_f32 v114, v232, v114
    ds_write_b128 v21, v[164:167] offset:0
    v_mul_f32 v115, v232, v115
    v_mfma_f32_16x16x32_bf16 v[84:87], a[52:55], v[228:231], v[84:87]
    v_mul_f32 v124, v232, v124
    v_mul_f32 v125, v232, v125
    v_mul_f32 v126, v232, v126
    v_mul_f32 v127, v232, v127
    v_cvt_pk_bf16_f32 v168, v112, v113
    v_mfma_f32_16x16x32_bf16 v[96:99], a[56:59], v[228:231], v[96:99]
    v_cvt_pk_bf16_f32 v169, v114, v115
    v_cvt_pk_bf16_f32 v170, v124, v125
    v_cvt_pk_bf16_f32 v171, v126, v127
    v_mul_f32 v136, v232, v136
    v_mfma_f32_16x16x32_bf16 v[108:111], a[60:63], v[228:231], v[108:111]
    v_mul_f32 v137, v232, v137
    v_permlane16_swap_b32 v168, v170
    v_permlane16_swap_b32 v169, v171
    v_mul_f32 v138, v232, v138
    ds_write_b128 v22, v[168:171] offset:0
    v_mfma_f32_16x16x32_bf16 v[120:123], a[64:67], v[228:231], v[120:123]
    v_mul_f32 v139, v232, v139
    v_mul_f32 v148, v232, v148
    v_mul_f32 v149, v232, v149
    v_mul_f32 v150, v232, v150
    v_mul_f32 v151, v232, v151
    v_mfma_f32_16x16x32_bf16 v[132:135], a[68:71], v[228:231], v[132:135]
    v_cvt_pk_bf16_f32 v172, v136, v137
    v_cvt_pk_bf16_f32 v173, v138, v139
    v_cvt_pk_bf16_f32 v174, v148, v149
    v_cvt_pk_bf16_f32 v175, v150, v151
    s_nop 0
    v_mfma_f32_16x16x32_bf16 v[144:147], a[72:75], v[228:231], v[144:147]
    s_nop 0
    v_permlane16_swap_b32 v172, v174
    v_permlane16_swap_b32 v173, v175
    s_nop 0
    ds_write_b128 v23, v[172:175] offset:0
    v_mfma_f32_16x16x32_bf16 v[156:159], a[76:79], v[228:231], v[156:159]
    v_mul_f32 v68, v234, v68
    v_mul_f32 v69, v234, v69
    v_mul_f32 v70, v234, v70
    v_mul_f32 v71, v234, v71
    v_mul_f32 v80, v234, v80
    v_mul_f32 v81, v234, v81
    s_waitcnt lgkmcnt(0)
    ds_read_b128 v[184:187], v2 offset:0
    ds_read_b128 v[188:191], v3 offset:1024
    ds_read_b128 v[192:195], v4 offset:2048
    ds_read_b128 v[196:199], v5 offset:3072
    v_mul_f32 v82, v234, v82
    v_mul_f32 v83, v234, v83
    v_cvt_pk_bf16_f32 v208, v68, v69
    v_cvt_pk_bf16_f32 v209, v70, v71
    v_cvt_pk_bf16_f32 v210, v80, v81
    v_cvt_pk_bf16_f32 v211, v82, v83
    v_mul_f32 v92, v234, v92
    v_mul_f32 v93, v234, v93
    v_permlane16_swap_b32 v208, v210
    v_permlane16_swap_b32 v209, v211
    v_mul_f32 v94, v234, v94
    ds_write_b128 v20, v[208:211] offset:4096
    s_waitcnt lgkmcnt(4)
    buffer_store_dwordx4 v[184:187], v238, s[24:27], s47 offen nt
    v_mul_f32 v95, v234, v95
    v_mul_f32 v104, v234, v104
    v_mul_f32 v105, v234, v105
    v_mul_f32 v106, v234, v106
    v_mul_f32 v107, v234, v107
    v_cvt_pk_bf16_f32 v212, v92, v93
    v_cvt_pk_bf16_f32 v213, v94, v95
    v_cvt_pk_bf16_f32 v214, v104, v105
    v_cvt_pk_bf16_f32 v215, v106, v107
    s_waitcnt lgkmcnt(3)
    buffer_store_dwordx4 v[188:191], v238, s[24:27], s47 offen offset:1024 nt
    v_mul_f32 v116, v234, v116
    v_mul_f32 v117, v234, v117
    v_permlane16_swap_b32 v212, v214
    v_permlane16_swap_b32 v213, v215
    v_mul_f32 v118, v234, v118
    ds_write_b128 v21, v[212:215] offset:4096
    v_mul_f32 v119, v234, v119
    v_mul_f32 v128, v234, v128
    v_mul_f32 v129, v234, v129
    s_waitcnt lgkmcnt(3)
    buffer_store_dwordx4 v[192:195], v238, s[24:27], s47 offen offset:2048 nt
    v_mul_f32 v130, v234, v130
    v_mul_f32 v131, v234, v131
    v_cvt_pk_bf16_f32 v216, v116, v117
    v_cvt_pk_bf16_f32 v217, v118, v119
    v_cvt_pk_bf16_f32 v218, v128, v129
    v_cvt_pk_bf16_f32 v219, v130, v131
    v_mul_f32 v140, v234, v140
    v_mul_f32 v141, v234, v141
    v_permlane16_swap_b32 v216, v218
    s_waitcnt lgkmcnt(2)
    buffer_store_dwordx4 v[196:199], v238, s[24:27], s47 offen offset:3072 nt
    v_permlane16_swap_b32 v217, v219
    v_mul_f32 v142, v234, v142
    ds_write_b128 v22, v[216:219] offset:4096
    v_mul_f32 v143, v234, v143
    v_mul_f32 v152, v234, v152
    v_mul_f32 v153, v234, v153
    v_mul_f32 v154, v234, v154
    v_mul_f32 v155, v234, v155
    v_cvt_pk_bf16_f32 v220, v140, v141
    v_cvt_pk_bf16_f32 v221, v142, v143
    v_cvt_pk_bf16_f32 v222, v152, v153
    v_cvt_pk_bf16_f32 v223, v154, v155
    s_nop 0
    s_nop 0
    v_permlane16_swap_b32 v220, v222
    v_permlane16_swap_b32 v221, v223
    s_nop 0
    ds_write_b128 v23, v[220:223] offset:4096
    v_mul_f32 v72, v244, v72
    v_mul_f32 v73, v244, v73
    v_mul_f32 v74, v244, v74
    v_mul_f32 v75, v244, v75
    v_mul_f32 v84, v244, v84
    v_mul_f32 v85, v244, v85
    s_waitcnt lgkmcnt(0)
    ds_read_b128 v[48:51], v2 offset:4096
    ds_read_b128 v[52:55], v3 offset:5120
    ds_read_b128 v[56:59], v4 offset:6144
    ds_read_b128 v[60:63], v5 offset:7168
    v_mul_f32 v86, v244, v86
    v_mul_f32 v87, v244, v87
    v_cvt_pk_bf16_f32 v160, v72, v73
    v_cvt_pk_bf16_f32 v161, v74, v75
    v_cvt_pk_bf16_f32 v162, v84, v85
    v_cvt_pk_bf16_f32 v163, v86, v87
    v_mul_f32 v96, v244, v96
    v_mul_f32 v97, v244, v97
    v_permlane16_swap_b32 v160, v162
    v_permlane16_swap_b32 v161, v163
    v_mul_f32 v98, v244, v98
    ds_write_b128 v20, v[160:163] offset:8192
    s_waitcnt lgkmcnt(4)
    buffer_store_dwordx4 v[48:51], v238, s[24:27], s48 offen nt
    v_mul_f32 v99, v244, v99
    v_mul_f32 v108, v244, v108
    v_mul_f32 v109, v244, v109
    v_mul_f32 v110, v244, v110
    v_mul_f32 v111, v244, v111
    v_cvt_pk_bf16_f32 v164, v96, v97
    v_cvt_pk_bf16_f32 v165, v98, v99
    v_cvt_pk_bf16_f32 v166, v108, v109
    v_cvt_pk_bf16_f32 v167, v110, v111
    s_waitcnt lgkmcnt(3)
    buffer_store_dwordx4 v[52:55], v238, s[24:27], s48 offen offset:1024 nt
    v_mul_f32 v120, v244, v120
    v_mul_f32 v121, v244, v121
    v_permlane16_swap_b32 v164, v166
    v_permlane16_swap_b32 v165, v167
    v_mul_f32 v122, v244, v122
    ds_write_b128 v21, v[164:167] offset:8192
    v_mul_f32 v123, v244, v123
    v_mul_f32 v132, v244, v132
    v_mul_f32 v133, v244, v133
    s_waitcnt lgkmcnt(3)
    buffer_store_dwordx4 v[56:59], v238, s[24:27], s48 offen offset:2048 nt
    v_mul_f32 v134, v244, v134
    v_mul_f32 v135, v244, v135
    v_cvt_pk_bf16_f32 v168, v120, v121
    v_cvt_pk_bf16_f32 v169, v122, v123
    v_cvt_pk_bf16_f32 v170, v132, v133
    v_cvt_pk_bf16_f32 v171, v134, v135
    v_mul_f32 v144, v244, v144
    v_mul_f32 v145, v244, v145
    v_permlane16_swap_b32 v168, v170
    s_waitcnt lgkmcnt(2)
    buffer_store_dwordx4 v[60:63], v238, s[24:27], s48 offen offset:3072 nt
    v_permlane16_swap_b32 v169, v171
    v_mul_f32 v146, v244, v146
    ds_write_b128 v22, v[168:171] offset:8192
    v_mul_f32 v147, v244, v147
    v_mul_f32 v156, v244, v156
    v_mul_f32 v157, v244, v157
    v_mul_f32 v158, v244, v158
    v_mul_f32 v159, v244, v159
    v_cvt_pk_bf16_f32 v172, v144, v145
    v_cvt_pk_bf16_f32 v173, v146, v147
    v_cvt_pk_bf16_f32 v174, v156, v157
    v_cvt_pk_bf16_f32 v175, v158, v159
    s_nop 0
    s_nop 0
    v_permlane16_swap_b32 v172, v174
    v_permlane16_swap_b32 v173, v175
    s_nop 0
    ds_write_b128 v23, v[172:175] offset:8192
    s_waitcnt lgkmcnt(0)
    ds_read_b128 v[184:187], v2 offset:8192
    ds_read_b128 v[188:191], v3 offset:9216
    ds_read_b128 v[192:195], v4 offset:10240
    ds_read_b128 v[196:199], v5 offset:11264
    s_waitcnt lgkmcnt(3)
    buffer_store_dwordx4 v[184:187], v238, s[24:27], s49 offen nt
    s_waitcnt lgkmcnt(2)
    buffer_store_dwordx4 v[188:191], v238, s[24:27], s49 offen offset:1024 nt
    s_waitcnt lgkmcnt(1)
    buffer_store_dwordx4 v[192:195], v238, s[24:27], s49 offen offset:2048 nt
    s_waitcnt lgkmcnt(0)
    buffer_store_dwordx4 v[196:199], v238, s[24:27], s49 offen offset:3072 nt
    s_endpgm
L_safe:
    s_waitcnt vmcnt(0) lgkmcnt(0)
    s_barrier
    v_lshrrev_b32 v32, 4, v1
    v_and_b32 v33, 15, v1
    v_xor_b32 v34, v33, v32
    v_lshlrev_b32 v34, 4, v34
    v_lshl_add_u32 v2, v32, 8, v34
    v_xor_b32 v3, 64, v2
    v_xor_b32 v4, 128, v2
    v_xor_b32 v5, 192, v2
    v_lshlrev_b32 v34, 1, v32
    v_xor_b32 v34, v33, v34
    v_lshlrev_b32 v34, 4, v34
    v_lshl_add_u32 v6, v32, 8, v34
    v_xor_b32 v7, 0x80, v6
    s_lshl_b32 s38, s28, 12
    s_mov_b32 s39, s38
    s_mov_b32 s36, s38
    s_mov_b32 s37, s38
    s_add_u32 s30, s47, 114688
L_safe2:
    s_mov_b32 m0, s30
    s_nop 0
    buffer_load_dwordx4 v2, s[12:15], s47 offen nt lds
    buffer_load_dwordx4 v3, s[12:15], s47 offen offset:1024 nt lds
    buffer_load_dwordx4 v4, s[12:15], s47 offen offset:2048 nt lds
    buffer_load_dwordx4 v5, s[12:15], s47 offen offset:3072 nt lds
    s_add_u32 s40, s30, 4096
    s_mov_b32 m0, s40
    s_nop 0
    buffer_load_dwordx4 v2, s[12:15], s48 offen nt lds
    buffer_load_dwordx4 v3, s[12:15], s48 offen offset:1024 nt lds
    buffer_load_dwordx4 v4, s[12:15], s48 offen offset:2048 nt lds
    buffer_load_dwordx4 v5, s[12:15], s48 offen offset:3072 nt lds
    s_add_u32 s40, s30, 8192
    s_mov_b32 m0, s40
    s_nop 0
    buffer_load_dwordx4 v2, s[12:15], s49 offen nt lds
    buffer_load_dwordx4 v3, s[12:15], s49 offen offset:1024 nt lds
    buffer_load_dwordx4 v4, s[12:15], s49 offen offset:2048 nt lds
    buffer_load_dwordx4 v5, s[12:15], s49 offen offset:3072 nt lds
    s_mov_b32 m0, s38
    s_add_u32 s38, s38, 16384
    buffer_load_dwordx4 v2, s[16:19], s36 offen nt lds
    buffer_load_dwordx4 v3, s[16:19], s36 offen offset:1024 nt lds
    buffer_load_dwordx4 v4, s[16:19], s36 offen offset:2048 nt lds
    buffer_load_dwordx4 v5, s[16:19], s36 offen offset:3072 nt lds
    s_add_u32 s36, s36, 16384
    s_and_b32 s38, s38, 0xffff
    s_getpc_b64 s[42:43]
    s_lshl_b32 s41, s28, 10
    v_lshlrev_b32 v35, 4, v1
    v_add_u32 v35, s41, v35
    global_load_dwordx4 v[208:211], v35, s[42:43]
    v_add_u32 v35, 4096, v35
    global_load_dwordx4 v[212:215], v35, s[42:43]
    v_add_u32 v35, 4096, v35
    global_load_dwordx4 v[216:219], v35, s[42:43]
    v_add_u32 v35, 4096, v35
    global_load_dwordx4 v[220:223], v35, s[42:43]
    v_and_b32 v32, 15, v1
    v_lshrrev_b32 v33, 4, v1
    v_xor_b32 v34, v32, v33
    v_lshlrev_b32 v34, 4, v34
    v_lshl_add_u32 v8, v32, 8, v34
    v_lshrrev_b32 v32, 2, v1
    v_and_b32 v33, 7, v32
    v_lshlrev_b32 v33, 5, v33
    v_lshl_add_u32 v33, v32, 8, v33
    v_and_b32 v32, 3, v1
    v_lshl_add_u32 v9, v32, 3, v33
    v_mov_b32 v64, 0
    v_mov_b32 v65, 0
    v_mov_b32 v66, 0
    v_mov_b32 v67, 0
    v_mov_b32 v68, 0
    v_mov_b32 v69, 0
    v_mov_b32 v70, 0
    v_mov_b32 v71, 0
    v_mov_b32 v72, 0
    v_mov_b32 v73, 0
    v_mov_b32 v74, 0
    v_mov_b32 v75, 0
    v_mov_b32 v76, 0
    v_mov_b32 v77, 0
    v_mov_b32 v78, 0
    v_mov_b32 v79, 0
    v_mov_b32 v80, 0
    v_mov_b32 v81, 0
    v_mov_b32 v82, 0
    v_mov_b32 v83, 0
    v_mov_b32 v84, 0
    v_mov_b32 v85, 0
    v_mov_b32 v86, 0
    v_mov_b32 v87, 0
    v_mov_b32 v88, 0
    v_mov_b32 v89, 0
    v_mov_b32 v90, 0
    v_mov_b32 v91, 0
    v_mov_b32 v92, 0
    v_mov_b32 v93, 0
    v_mov_b32 v94, 0
    v_mov_b32 v95, 0
    v_mov_b32 v96, 0
    v_mov_b32 v97, 0
    v_mov_b32 v98, 0
    v_mov_b32 v99, 0
    v_mov_b32 v100, 0
    v_mov_b32 v101, 0
    v_mov_b32 v102, 0
    v_mov_b32 v103, 0
    v_mov_b32 v104, 0
    v_mov_b32 v105, 0
    v_mov_b32 v106, 0
    v_mov_b32 v107, 0
    v_mov_b32 v108, 0
    v_mov_b32 v109, 0
    v_mov_b32 v110, 0
    v_mov_b32 v111, 0
    v_mov_b32 v112, 0
    v_mov_b32 v113, 0
    v_mov_b32 v114, 0
    v_mov_b32 v115, 0
    v_mov_b32 v116, 0
    v_mov_b32 v117, 0
    v_mov_b32 v118, 0
    v_mov_b32 v119, 0
    v_mov_b32 v120, 0
    v_mov_b32 v121, 0
    v_mov_b32 v122, 0
    v_mov_b32 v123, 0
    v_mov_b32 v124, 0
    v_mov_b32 v125, 0
    v_mov_b32 v126, 0
    v_mov_b32 v127, 0
    v_mov_b32 v128, 0
    v_mov_b32 v129, 0
    v_mov_b32 v130, 0
    v_mov_b32 v131, 0
    v_mov_b32 v132, 0
    v_mov_b32 v133, 0
    v_mov_b32 v134, 0
    v_mov_b32 v135, 0
    v_mov_b32 v136, 0
    v_mov_b32 v137, 0
    v_mov_b32 v138, 0
    v_mov_b32 v139, 0
    v_mov_b32 v140, 0
    v_mov_b32 v141, 0
    v_mov_b32 v142, 0
    v_mov_b32 v143, 0
    v_mov_b32 v144, 0
    v_mov_b32 v145, 0
    v_mov_b32 v146, 0
    v_mov_b32 v147, 0
    v_mov_b32 v148, 0
    v_mov_b32 v149, 0
    v_mov_b32 v150, 0
    v_mov_b32 v151, 0
    v_mov_b32 v152, 0
    v_mov_b32 v153, 0
    v_mov_b32 v154, 0
    v_mov_b32 v155, 0
    v_mov_b32 v156, 0
    v_mov_b32 v157, 0
    v_mov_b32 v158, 0
    v_mov_b32 v159, 0
    v_mov_b32 v10, 0
    v_mov_b32 v13, 0
    v_mov_b32 v11, 0
    v_mov_b32 v14, 0
    v_mov_b32 v12, 0
    v_mov_b32 v15, 0
    v_and_b32 v240, 15, v1
    v_bfe_u32 v241, v1, 4, 1
    v_lshrrev_b32 v242, 5, v1
    v_lshl_add_u32 v241, v241, 1, v242
    v_xor_b32 v241, v241, v240
    v_lshlrev_b32 v241, 4, v241
    v_lshl_add_u32 v243, v240, 8, v241
    v_lshlrev_b32 v238, 4, v1
    s_waitcnt vmcnt(8)
    s_mov_b32 m0, s38
    s_add_u32 s38, s38, 16384
    buffer_load_dwordx4 v2, s[16:19], s36 offen nt lds
    buffer_load_dwordx4 v3, s[16:19], s36 offen offset:1024 nt lds
    buffer_load_dwordx4 v4, s[16:19], s36 offen offset:2048 nt lds
    buffer_load_dwordx4 v5, s[16:19], s36 offen offset:3072 nt lds
    s_add_u32 s36, s36, 16384
    s_and_b32 s38, s38, 0xffff
    s_add_u32 m0, s39, 65536
    s_add_u32 s39, s39, 16384
    buffer_load_dwordx4 v6, s[20:23], s37 offen nt lds
    buffer_load_dwordx4 v7, s[20:23], s37 offen offset:1024 nt lds
    buffer_load_dwordx4 v6, s[20:23], s37 offen offset:2048 nt lds
    buffer_load_dwordx4 v7, s[20:23], s37 offen offset:3072 nt lds
    s_add_u32 s37, s37, 16384
    s_and_b32 s39, s39, 0xffff
    v_add_u32 v20, s30, v8
    v_xor_b32 v21, 64, v20
    v_xor_b32 v22, 128, v20
    v_xor_b32 v23, 192, v20
    ds_read_b128 v[160:163], v20
    ds_read_b128 v[164:167], v21
    ds_read_b128 v[168:171], v22
    ds_read_b128 v[172:175], v23
    ds_read_b128 v[176:179], v20 offset:4096
    ds_read_b128 v[180:183], v21 offset:4096
    ds_read_b128 v[184:187], v22 offset:4096
    ds_read_b128 v[188:191], v23 offset:4096
    ds_read_b128 v[192:195], v20 offset:8192
    ds_read_b128 v[196:199], v21 offset:8192
    ds_read_b128 v[200:203], v22 offset:8192
    ds_read_b128 v[204:207], v23 offset:8192
    s_waitcnt lgkmcnt(11)
    v_lshlrev_b32 v36, 16, v160
    v_and_b32 v37, 0xffff0000, v160
    v_mul_f32 v36, s32, v36
    v_mul_f32 v37, s32, v37
    v_cvt_pk_bf16_f32 v160, v36, v37
    v_lshlrev_b32 v38, 16, v161
    v_and_b32 v39, 0xffff0000, v161
    v_mul_f32 v38, s32, v38
    v_mul_f32 v39, s32, v39
    v_cvt_pk_bf16_f32 v161, v38, v39
    v_accvgpr_write_b32 a0, v160
    v_lshlrev_b32 v40, 16, v162
    v_and_b32 v41, 0xffff0000, v162
    v_mul_f32 v40, s32, v40
    v_mul_f32 v41, s32, v41
    v_cvt_pk_bf16_f32 v162, v40, v41
    v_accvgpr_write_b32 a1, v161
    v_lshlrev_b32 v36, 16, v163
    v_and_b32 v37, 0xffff0000, v163
    v_mul_f32 v36, s32, v36
    v_mul_f32 v37, s32, v37
    v_cvt_pk_bf16_f32 v163, v36, v37
    v_accvgpr_write_b32 a2, v162
    v_accvgpr_write_b32 a3, v163
    s_waitcnt lgkmcnt(10)
    v_lshlrev_b32 v36, 16, v164
    v_and_b32 v37, 0xffff0000, v164
    v_mul_f32 v36, s32, v36
    v_mul_f32 v37, s32, v37
    v_cvt_pk_bf16_f32 v164, v36, v37
    v_lshlrev_b32 v38, 16, v165
    v_and_b32 v39, 0xffff0000, v165
    v_mul_f32 v38, s32, v38
    v_mul_f32 v39, s32, v39
    v_cvt_pk_bf16_f32 v165, v38, v39
    v_accvgpr_write_b32 a4, v164
    v_lshlrev_b32 v40, 16, v166
    v_and_b32 v41, 0xffff0000, v166
    v_mul_f32 v40, s32, v40
    v_mul_f32 v41, s32, v41
    v_cvt_pk_bf16_f32 v166, v40, v41
    v_accvgpr_write_b32 a5, v165
    v_lshlrev_b32 v36, 16, v167
    v_and_b32 v37, 0xffff0000, v167
    v_mul_f32 v36, s32, v36
    v_mul_f32 v37, s32, v37
    v_cvt_pk_bf16_f32 v167, v36, v37
    v_accvgpr_write_b32 a6, v166
    v_accvgpr_write_b32 a7, v167
    s_waitcnt lgkmcnt(9)
    v_lshlrev_b32 v36, 16, v168
    v_and_b32 v37, 0xffff0000, v168
    v_mul_f32 v36, s32, v36
    v_mul_f32 v37, s32, v37
    v_cvt_pk_bf16_f32 v168, v36, v37
    v_lshlrev_b32 v38, 16, v169
    v_and_b32 v39, 0xffff0000, v169
    v_mul_f32 v38, s32, v38
    v_mul_f32 v39, s32, v39
    v_cvt_pk_bf16_f32 v169, v38, v39
    v_accvgpr_write_b32 a8, v168
    v_lshlrev_b32 v40, 16, v170
    v_and_b32 v41, 0xffff0000, v170
    v_mul_f32 v40, s32, v40
    v_mul_f32 v41, s32, v41
    v_cvt_pk_bf16_f32 v170, v40, v41
    v_accvgpr_write_b32 a9, v169
    v_lshlrev_b32 v36, 16, v171
    v_and_b32 v37, 0xffff0000, v171
    v_mul_f32 v36, s32, v36
    v_mul_f32 v37, s32, v37
    v_cvt_pk_bf16_f32 v171, v36, v37
    v_accvgpr_write_b32 a10, v170
    v_accvgpr_write_b32 a11, v171
    s_waitcnt lgkmcnt(8)
    v_lshlrev_b32 v36, 16, v172
    v_and_b32 v37, 0xffff0000, v172
    v_mul_f32 v36, s32, v36
    v_mul_f32 v37, s32, v37
    v_cvt_pk_bf16_f32 v172, v36, v37
    v_lshlrev_b32 v38, 16, v173
    v_and_b32 v39, 0xffff0000, v173
    v_mul_f32 v38, s32, v38
    v_mul_f32 v39, s32, v39
    v_cvt_pk_bf16_f32 v173, v38, v39
    v_accvgpr_write_b32 a12, v172
    v_lshlrev_b32 v40, 16, v174
    v_and_b32 v41, 0xffff0000, v174
    v_mul_f32 v40, s32, v40
    v_mul_f32 v41, s32, v41
    v_cvt_pk_bf16_f32 v174, v40, v41
    v_accvgpr_write_b32 a13, v173
    v_lshlrev_b32 v36, 16, v175
    v_and_b32 v37, 0xffff0000, v175
    v_mul_f32 v36, s32, v36
    v_mul_f32 v37, s32, v37
    v_cvt_pk_bf16_f32 v175, v36, v37
    v_accvgpr_write_b32 a14, v174
    v_accvgpr_write_b32 a15, v175
    s_waitcnt lgkmcnt(7)
    v_lshlrev_b32 v36, 16, v176
    v_and_b32 v37, 0xffff0000, v176
    v_mul_f32 v36, s32, v36
    v_mul_f32 v37, s32, v37
    v_cvt_pk_bf16_f32 v176, v36, v37
    v_lshlrev_b32 v38, 16, v177
    v_and_b32 v39, 0xffff0000, v177
    v_mul_f32 v38, s32, v38
    v_mul_f32 v39, s32, v39
    v_cvt_pk_bf16_f32 v177, v38, v39
    v_accvgpr_write_b32 a16, v176
    v_lshlrev_b32 v40, 16, v178
    v_and_b32 v41, 0xffff0000, v178
    v_mul_f32 v40, s32, v40
    v_mul_f32 v41, s32, v41
    v_cvt_pk_bf16_f32 v178, v40, v41
    v_accvgpr_write_b32 a17, v177
    v_lshlrev_b32 v36, 16, v179
    v_and_b32 v37, 0xffff0000, v179
    v_mul_f32 v36, s32, v36
    v_mul_f32 v37, s32, v37
    v_cvt_pk_bf16_f32 v179, v36, v37
    v_accvgpr_write_b32 a18, v178
    v_accvgpr_write_b32 a19, v179
    s_waitcnt lgkmcnt(6)
    v_lshlrev_b32 v36, 16, v180
    v_and_b32 v37, 0xffff0000, v180
    v_mul_f32 v36, s32, v36
    v_mul_f32 v37, s32, v37
    v_cvt_pk_bf16_f32 v180, v36, v37
    v_lshlrev_b32 v38, 16, v181
    v_and_b32 v39, 0xffff0000, v181
    v_mul_f32 v38, s32, v38
    v_mul_f32 v39, s32, v39
    v_cvt_pk_bf16_f32 v181, v38, v39
    v_accvgpr_write_b32 a20, v180
    v_lshlrev_b32 v40, 16, v182
    v_and_b32 v41, 0xffff0000, v182
    v_mul_f32 v40, s32, v40
    v_mul_f32 v41, s32, v41
    v_cvt_pk_bf16_f32 v182, v40, v41
    v_accvgpr_write_b32 a21, v181
    v_lshlrev_b32 v36, 16, v183
    v_and_b32 v37, 0xffff0000, v183
    v_mul_f32 v36, s32, v36
    v_mul_f32 v37, s32, v37
    v_cvt_pk_bf16_f32 v183, v36, v37
    v_accvgpr_write_b32 a22, v182
    v_accvgpr_write_b32 a23, v183
    s_waitcnt lgkmcnt(5)
    v_lshlrev_b32 v36, 16, v184
    v_and_b32 v37, 0xffff0000, v184
    v_mul_f32 v36, s32, v36
    v_mul_f32 v37, s32, v37
    v_cvt_pk_bf16_f32 v184, v36, v37
    v_lshlrev_b32 v38, 16, v185
    v_and_b32 v39, 0xffff0000, v185
    v_mul_f32 v38, s32, v38
    v_mul_f32 v39, s32, v39
    v_cvt_pk_bf16_f32 v185, v38, v39
    v_accvgpr_write_b32 a24, v184
    v_lshlrev_b32 v40, 16, v186
    v_and_b32 v41, 0xffff0000, v186
    v_mul_f32 v40, s32, v40
    v_mul_f32 v41, s32, v41
    v_cvt_pk_bf16_f32 v186, v40, v41
    v_accvgpr_write_b32 a25, v185
    v_lshlrev_b32 v36, 16, v187
    v_and_b32 v37, 0xffff0000, v187
    v_mul_f32 v36, s32, v36
    v_mul_f32 v37, s32, v37
    v_cvt_pk_bf16_f32 v187, v36, v37
    v_accvgpr_write_b32 a26, v186
    v_accvgpr_write_b32 a27, v187
    s_waitcnt lgkmcnt(4)
    v_lshlrev_b32 v36, 16, v188
    v_and_b32 v37, 0xffff0000, v188
    v_mul_f32 v36, s32, v36
    v_mul_f32 v37, s32, v37
    v_cvt_pk_bf16_f32 v188, v36, v37
    v_lshlrev_b32 v38, 16, v189
    v_and_b32 v39, 0xffff0000, v189
    v_mul_f32 v38, s32, v38
    v_mul_f32 v39, s32, v39
    v_cvt_pk_bf16_f32 v189, v38, v39
    v_accvgpr_write_b32 a28, v188
    v_lshlrev_b32 v40, 16, v190
    v_and_b32 v41, 0xffff0000, v190
    v_mul_f32 v40, s32, v40
    v_mul_f32 v41, s32, v41
    v_cvt_pk_bf16_f32 v190, v40, v41
    v_accvgpr_write_b32 a29, v189
    v_lshlrev_b32 v36, 16, v191
    v_and_b32 v37, 0xffff0000, v191
    v_mul_f32 v36, s32, v36
    v_mul_f32 v37, s32, v37
    v_cvt_pk_bf16_f32 v191, v36, v37
    v_accvgpr_write_b32 a30, v190
    v_accvgpr_write_b32 a31, v191
    s_waitcnt lgkmcnt(3)
    v_lshlrev_b32 v36, 16, v192
    v_and_b32 v37, 0xffff0000, v192
    v_mul_f32 v36, s32, v36
    v_mul_f32 v37, s32, v37
    v_cvt_pk_bf16_f32 v192, v36, v37
    v_lshlrev_b32 v38, 16, v193
    v_and_b32 v39, 0xffff0000, v193
    v_mul_f32 v38, s32, v38
    v_mul_f32 v39, s32, v39
    v_cvt_pk_bf16_f32 v193, v38, v39
    v_accvgpr_write_b32 a32, v192
    v_lshlrev_b32 v40, 16, v194
    v_and_b32 v41, 0xffff0000, v194
    v_mul_f32 v40, s32, v40
    v_mul_f32 v41, s32, v41
    v_cvt_pk_bf16_f32 v194, v40, v41
    v_accvgpr_write_b32 a33, v193
    v_lshlrev_b32 v36, 16, v195
    v_and_b32 v37, 0xffff0000, v195
    v_mul_f32 v36, s32, v36
    v_mul_f32 v37, s32, v37
    v_cvt_pk_bf16_f32 v195, v36, v37
    v_accvgpr_write_b32 a34, v194
    v_accvgpr_write_b32 a35, v195
    s_waitcnt lgkmcnt(2)
    v_lshlrev_b32 v36, 16, v196
    v_and_b32 v37, 0xffff0000, v196
    v_mul_f32 v36, s32, v36
    v_mul_f32 v37, s32, v37
    v_cvt_pk_bf16_f32 v196, v36, v37
    v_lshlrev_b32 v38, 16, v197
    v_and_b32 v39, 0xffff0000, v197
    v_mul_f32 v38, s32, v38
    v_mul_f32 v39, s32, v39
    v_cvt_pk_bf16_f32 v197, v38, v39
    v_accvgpr_write_b32 a36, v196
    v_lshlrev_b32 v40, 16, v198
    v_and_b32 v41, 0xffff0000, v198
    v_mul_f32 v40, s32, v40
    v_mul_f32 v41, s32, v41
    v_cvt_pk_bf16_f32 v198, v40, v41
    v_accvgpr_write_b32 a37, v197
    v_lshlrev_b32 v36, 16, v199
    v_and_b32 v37, 0xffff0000, v199
    v_mul_f32 v36, s32, v36
    v_mul_f32 v37, s32, v37
    v_cvt_pk_bf16_f32 v199, v36, v37
    v_accvgpr_write_b32 a38, v198
    v_accvgpr_write_b32 a39, v199
    s_waitcnt lgkmcnt(1)
    v_lshlrev_b32 v36, 16, v200
    v_and_b32 v37, 0xffff0000, v200
    v_mul_f32 v36, s32, v36
    v_mul_f32 v37, s32, v37
    v_cvt_pk_bf16_f32 v200, v36, v37
    v_lshlrev_b32 v38, 16, v201
    v_and_b32 v39, 0xffff0000, v201
    v_mul_f32 v38, s32, v38
    v_mul_f32 v39, s32, v39
    v_cvt_pk_bf16_f32 v201, v38, v39
    v_accvgpr_write_b32 a40, v200
    v_lshlrev_b32 v40, 16, v202
    v_and_b32 v41, 0xffff0000, v202
    v_mul_f32 v40, s32, v40
    v_mul_f32 v41, s32, v41
    v_cvt_pk_bf16_f32 v202, v40, v41
    v_accvgpr_write_b32 a41, v201
    v_lshlrev_b32 v36, 16, v203
    v_and_b32 v37, 0xffff0000, v203
    v_mul_f32 v36, s32, v36
    v_mul_f32 v37, s32, v37
    v_cvt_pk_bf16_f32 v203, v36, v37
    v_accvgpr_write_b32 a42, v202
    v_accvgpr_write_b32 a43, v203
    s_waitcnt lgkmcnt(0)
    v_lshlrev_b32 v36, 16, v204
    v_and_b32 v37, 0xffff0000, v204
    v_mul_f32 v36, s32, v36
    v_mul_f32 v37, s32, v37
    v_cvt_pk_bf16_f32 v204, v36, v37
    v_lshlrev_b32 v38, 16, v205
    v_and_b32 v39, 0xffff0000, v205
    v_mul_f32 v38, s32, v38
    v_mul_f32 v39, s32, v39
    v_cvt_pk_bf16_f32 v205, v38, v39
    v_accvgpr_write_b32 a44, v204
    v_lshlrev_b32 v40, 16, v206
    v_and_b32 v41, 0xffff0000, v206
    v_mul_f32 v40, s32, v40
    v_mul_f32 v41, s32, v41
    v_cvt_pk_bf16_f32 v206, v40, v41
    v_accvgpr_write_b32 a45, v205
    v_lshlrev_b32 v36, 16, v207
    v_and_b32 v37, 0xffff0000, v207
    v_mul_f32 v36, s32, v36
    v_mul_f32 v37, s32, v37
    v_cvt_pk_bf16_f32 v207, v36, v37
    v_accvgpr_write_b32 a46, v206
    v_accvgpr_write_b32 a47, v207
    s_waitcnt lgkmcnt(0)
    v_add_u32 v20, 0, v8
    v_xor_b32 v21, 64, v20
    v_xor_b32 v22, 128, v20
    v_xor_b32 v23, 192, v20
    v_add_u32 v24, 65536, v9
    v_xor_b32 v25, 32, v24
    v_xor_b32 v26, 64, v24
    v_xor_b32 v27, 96, v24
    v_xor_b32 v28, 128, v24
    v_xor_b32 v29, 160, v24
    v_xor_b32 v30, 192, v24
    v_xor_b32 v31, 224, v24
    s_waitcnt vmcnt(8)
    s_barrier
    ds_read_b128 a[48:51], v20
    ds_read_b128 a[52:55], v21
    ds_read_b128 a[56:59], v22
    ds_read_b128 a[60:63], v23
    ds_read_b128 a[64:67], v20 offset:4096
    ds_read_b128 a[68:71], v21 offset:4096
    ds_read_b128 a[72:75], v22 offset:4096
    ds_read_b128 a[76:79], v23 offset:4096
    s_mov_b32 m0, s38
    s_add_u32 s38, s38, 16384
    buffer_load_dwordx4 v2, s[16:19], s36 offen nt lds
    buffer_load_dwordx4 v3, s[16:19], s36 offen offset:1024 nt lds
    buffer_load_dwordx4 v4, s[16:19], s36 offen offset:2048 nt lds
    buffer_load_dwordx4 v5, s[16:19], s36 offen offset:3072 nt lds
    s_add_u32 s36, s36, 16384
    s_and_b32 s38, s38, 0xffff
    s_waitcnt lgkmcnt(7)
    v_mfma_f32_16x16x32_bf16 v[160:163], a[48:51], a[0:3], 0
    s_waitcnt lgkmcnt(6)
    v_mfma_f32_16x16x32_bf16 v[160:163], a[52:55], a[4:7], v[160:163]
    s_waitcnt lgkmcnt(5)
    v_mfma_f32_16x16x32_bf16 v[160:163], a[56:59], a[8:11], v[160:163]
    s_waitcnt lgkmcnt(4)
    v_mfma_f32_16x16x32_bf16 v[160:163], a[60:63], a[12:15], v[160:163]
    v_mfma_f32_16x16x32_bf16 v[168:171], a[48:51], a[16:19], 0
    ds_read_b128 a[112:115], v20 offset:8192
    v_mfma_f32_16x16x32_bf16 v[168:171], a[52:55], a[20:23], v[168:171]
    ds_read_b128 a[116:119], v21 offset:8192
    v_mfma_f32_16x16x32_bf16 v[168:171], a[56:59], a[24:27], v[168:171]
    ds_read_b128 a[120:123], v22 offset:8192
    v_mfma_f32_16x16x32_bf16 v[168:171], a[60:63], a[28:31], v[168:171]
    ds_read_b128 a[124:127], v23 offset:8192
    v_mfma_f32_16x16x32_bf16 v[176:179], a[48:51], a[32:35], 0
    ds_read_b128 a[128:131], v20 offset:12288
    v_mfma_f32_16x16x32_bf16 v[176:179], a[52:55], a[36:39], v[176:179]
    ds_read_b128 a[132:135], v21 offset:12288
    v_mfma_f32_16x16x32_bf16 v[176:179], a[56:59], a[40:43], v[176:179]
    ds_read_b128 a[136:139], v22 offset:12288
    v_mfma_f32_16x16x32_bf16 v[176:179], a[60:63], a[44:47], v[176:179]
    ds_read_b128 a[140:143], v23 offset:12288
    s_waitcnt lgkmcnt(11)
    v_mfma_f32_16x16x32_bf16 v[164:167], a[64:67], a[0:3], 0
    s_waitcnt lgkmcnt(10)
    v_mfma_f32_16x16x32_bf16 v[164:167], a[68:71], a[4:7], v[164:167]
    s_waitcnt lgkmcnt(9)
    v_mfma_f32_16x16x32_bf16 v[164:167], a[72:75], a[8:11], v[164:167]
    s_waitcnt lgkmcnt(8)
    v_mfma_f32_16x16x32_bf16 v[164:167], a[76:79], a[12:15], v[164:167]
    v_mfma_f32_16x16x32_bf16 v[172:175], a[64:67], a[16:19], 0
    v_mfma_f32_16x16x32_bf16 v[172:175], a[68:71], a[20:23], v[172:175]
    v_mfma_f32_16x16x32_bf16 v[172:175], a[72:75], a[24:27], v[172:175]
    v_mfma_f32_16x16x32_bf16 v[172:175], a[76:79], a[28:31], v[172:175]
    v_mfma_f32_16x16x32_bf16 v[180:183], a[64:67], a[32:35], 0
    v_mfma_f32_16x16x32_bf16 v[180:183], a[68:71], a[36:39], v[180:183]
    v_mfma_f32_16x16x32_bf16 v[180:183], a[72:75], a[40:43], v[180:183]
    v_mfma_f32_16x16x32_bf16 v[180:183], a[76:79], a[44:47], v[180:183]
    s_nop 7
    v_max3_f32 v48, v160, v161, v162
    v_max3_f32 v49, v163, v164, v165
    v_max3_f32 v48, v48, v166, v167
    v_max_f32 v48, v48, v49
    v_mov_b32 v49, v48
    s_nop 1
    v_permlane16_swap_b32 v48, v49
    s_nop 1
    v_max_f32 v48, v48, v49
    v_mov_b32 v49, v48
    s_nop 1
    v_permlane32_swap_b32 v48, v49
    s_nop 1
    v_max_f32 v48, v48, v49
    v_mov_b32 v42, v48
    v_sub_f32 v10, v10, v42
    v_mov_b32 v52, v10
    v_mov_b32 v53, v10
    v_mov_b32 v54, v10
    v_mov_b32 v55, v10
    v_sub_f32 v160, v160, v42
    v_sub_f32 v161, v161, v42
    v_sub_f32 v162, v162, v42
    v_sub_f32 v163, v163, v42
    v_sub_f32 v164, v164, v42
    v_sub_f32 v165, v165, v42
    v_sub_f32 v166, v166, v42
    v_sub_f32 v167, v167, v42
    v_max3_f32 v48, v168, v169, v170
    v_max3_f32 v49, v171, v172, v173
    v_max3_f32 v48, v48, v174, v175
    v_max_f32 v48, v48, v49
    v_mov_b32 v49, v48
    s_nop 1
    v_permlane16_swap_b32 v48, v49
    s_nop 1
    v_max_f32 v48, v48, v49
    v_mov_b32 v49, v48
    s_nop 1
    v_permlane32_swap_b32 v48, v49
    s_nop 1
    v_max_f32 v48, v48, v49
    v_mov_b32 v43, v48
    v_sub_f32 v11, v11, v43
    v_mov_b32 v56, v11
    v_mov_b32 v57, v11
    v_mov_b32 v58, v11
    v_mov_b32 v59, v11
    v_sub_f32 v168, v168, v43
    v_sub_f32 v169, v169, v43
    v_sub_f32 v170, v170, v43
    v_sub_f32 v171, v171, v43
    v_sub_f32 v172, v172, v43
    v_sub_f32 v173, v173, v43
    v_sub_f32 v174, v174, v43
    v_sub_f32 v175, v175, v43
    v_max3_f32 v48, v176, v177, v178
    v_max3_f32 v49, v179, v180, v181
    v_max3_f32 v48, v48, v182, v183
    v_max_f32 v48, v48, v49
    v_mov_b32 v49, v48
    s_nop 1
    v_permlane16_swap_b32 v48, v49
    s_nop 1
    v_max_f32 v48, v48, v49
    v_mov_b32 v49, v48
    s_nop 1
    v_permlane32_swap_b32 v48, v49
    s_nop 1
    v_max_f32 v48, v48, v49
    v_mov_b32 v44, v48
    v_sub_f32 v12, v12, v44
    v_mov_b32 v60, v12
    v_mov_b32 v61, v12
    v_mov_b32 v62, v12
    v_mov_b32 v63, v12
    v_sub_f32 v176, v176, v44
    v_sub_f32 v177, v177, v44
    v_sub_f32 v178, v178, v44
    v_sub_f32 v179, v179, v44
    v_sub_f32 v180, v180, v44
    v_sub_f32 v181, v181, v44
    v_sub_f32 v182, v182, v44
    v_sub_f32 v183, v183, v44
    s_nop 0
    s_waitcnt lgkmcnt(4)
    v_mfma_f32_16x16x32_bf16 v[184:187], a[112:115], a[0:3], v[52:55]
    v_mfma_f32_16x16x32_bf16 v[184:187], a[116:119], a[4:7], v[184:187]
    v_exp_f32 v36, v160
    v_exp_f32 v37, v161
    v_exp_f32 v38, v162
    v_cvt_pk_bf16_f32 v208, v36, v37
    v_add_f32 v16, v36, v37
    v_exp_f32 v39, v163
    v_mfma_f32_16x16x32_bf16 v[184:187], a[120:123], a[8:11], v[184:187]
    v_mfma_f32_16x16x32_bf16 v[184:187], a[124:127], a[12:15], v[184:187]
    s_add_u32 m0, s39, 65536
    s_add_u32 s39, s39, 16384
    buffer_load_dwordx4 v6, s[20:23], s37 offen nt lds
    buffer_load_dwordx4 v7, s[20:23], s37 offen offset:1024 nt lds
    buffer_load_dwordx4 v6, s[20:23], s37 offen offset:2048 nt lds
    buffer_load_dwordx4 v7, s[20:23], s37 offen offset:3072 nt lds
    s_add_u32 s37, s37, 16384
    s_and_b32 s39, s39, 0xffff
    v_mfma_f32_16x16x32_bf16 v[192:195], a[112:115], a[16:19], v[56:59]
    v_mfma_f32_16x16x32_bf16 v[192:195], a[116:119], a[20:23], v[192:195]
    v_exp_f32 v40, v164
    v_cvt_pk_bf16_f32 v209, v38, v39
    v_add_f32 v16, v16, v38
    v_exp_f32 v41, v165
    v_mfma_f32_16x16x32_bf16 v[192:195], a[120:123], a[24:27], v[192:195]
    v_mfma_f32_16x16x32_bf16 v[192:195], a[124:127], a[28:31], v[192:195]
    v_add_f32 v16, v16, v39
    v_exp_f32 v36, v166
    v_cvt_pk_bf16_f32 v210, v40, v41
    v_add_f32 v16, v16, v40
    v_exp_f32 v37, v167
    v_add_f32 v16, v16, v41
    v_mfma_f32_16x16x32_bf16 v[200:203], a[112:115], a[32:35], v[60:63]
    v_mfma_f32_16x16x32_bf16 v[200:203], a[116:119], a[36:39], v[200:203]
    v_exp_f32 v38, v168
    v_cvt_pk_bf16_f32 v211, v36, v37
    v_add_f32 v16, v16, v36
    v_exp_f32 v39, v169
    v_add_f32 v16, v16, v37
    v_exp_f32 v40, v170
    v_cvt_pk_bf16_f32 v212, v38, v39
    v_mfma_f32_16x16x32_bf16 v[200:203], a[120:123], a[40:43], v[200:203]
    v_mfma_f32_16x16x32_bf16 v[200:203], a[124:127], a[44:47], v[200:203]
    v_add_f32 v17, v38, v39
    v_exp_f32 v41, v171
    v_exp_f32 v36, v172
    v_cvt_pk_bf16_f32 v213, v40, v41
    v_add_f32 v17, v17, v40
    v_exp_f32 v37, v173
    s_waitcnt lgkmcnt(0)
    v_mfma_f32_16x16x32_bf16 v[188:191], a[128:131], a[0:3], v[52:55]
    v_mfma_f32_16x16x32_bf16 v[188:191], a[132:135], a[4:7], v[188:191]
    v_add_f32 v17, v17, v41
    v_exp_f32 v38, v174
    v_cvt_pk_bf16_f32 v214, v36, v37
    v_add_f32 v17, v17, v36
    v_exp_f32 v39, v175
    v_add_f32 v17, v17, v37
    v_mfma_f32_16x16x32_bf16 v[188:191], a[136:139], a[8:11], v[188:191]
    v_mfma_f32_16x16x32_bf16 v[188:191], a[140:143], a[12:15], v[188:191]
    v_exp_f32 v40, v176
    v_cvt_pk_bf16_f32 v215, v38, v39
    v_add_f32 v17, v17, v38
    v_exp_f32 v41, v177
    v_add_f32 v17, v17, v39
    v_exp_f32 v36, v178
    v_cvt_pk_bf16_f32 v216, v40, v41
    v_mfma_f32_16x16x32_bf16 v[196:199], a[128:131], a[16:19], v[56:59]
    v_mfma_f32_16x16x32_bf16 v[196:199], a[132:135], a[20:23], v[196:199]
    v_add_f32 v18, v40, v41
    v_exp_f32 v37, v179
    v_exp_f32 v38, v180
    v_cvt_pk_bf16_f32 v217, v36, v37
    v_add_f32 v18, v18, v36
    v_exp_f32 v39, v181
    v_mfma_f32_16x16x32_bf16 v[196:199], a[136:139], a[24:27], v[196:199]
    v_mfma_f32_16x16x32_bf16 v[196:199], a[140:143], a[28:31], v[196:199]
    v_add_f32 v18, v18, v37
    v_exp_f32 v40, v182
    v_cvt_pk_bf16_f32 v218, v38, v39
    v_add_f32 v18, v18, v38
    v_exp_f32 v41, v183
    v_add_f32 v18, v18, v39
    v_add_f32 v18, v18, v40
    v_mfma_f32_16x16x32_bf16 v[204:207], a[128:131], a[32:35], v[60:63]
    v_mfma_f32_16x16x32_bf16 v[204:207], a[132:135], a[36:39], v[204:207]
    v_add_f32 v18, v18, v41
    v_cvt_pk_bf16_f32 v219, v40, v41
    v_max3_f32 v32, v16, v17, v18
    v_cmp_nge_f32 vcc, 0x45800000, v32
    v_mfma_f32_16x16x32_bf16 v[204:207], a[136:139], a[40:43], v[204:207]
    v_mfma_f32_16x16x32_bf16 v[204:207], a[140:143], a[44:47], v[204:207]
    s_cmp_lt_u32 s34, 5
    s_cbranch_scc1 L_lb7
    s_mov_b32 m0, s38
    s_add_u32 s38, s38, 16384
    buffer_load_dwordx4 v2, s[16:19], s36 offen nt lds
    buffer_load_dwordx4 v3, s[16:19], s36 offen offset:1024 nt lds
    buffer_load_dwordx4 v4, s[16:19], s36 offen offset:2048 nt lds
    buffer_load_dwordx4 v5, s[16:19], s36 offen offset:3072 nt lds
    s_add_u32 s36, s36, 16384
    s_and_b32 s38, s38, 0xffff
    s_add_u32 m0, s39, 65536
    s_add_u32 s39, s39, 16384
    buffer_load_dwordx4 v6, s[20:23], s37 offen nt lds
    buffer_load_dwordx4 v7, s[20:23], s37 offen offset:1024 nt lds
    buffer_load_dwordx4 v6, s[20:23], s37 offen offset:2048 nt lds
    buffer_load_dwordx4 v7, s[20:23], s37 offen offset:3072 nt lds
    s_add_u32 s37, s37, 16384
    s_and_b32 s39, s39, 0xffff
    s_waitcnt vmcnt(0)
L_lb7:
    s_waitcnt vmcnt(8) lgkmcnt(0)
    s_barrier
    ds_read_b128 a[48:51], v20 offset:16384
    ds_read_b128 a[52:55], v21 offset:16384
    ds_read_b128 a[56:59], v22 offset:16384
    ds_read_b128 a[60:63], v23 offset:16384
    ds_read_b128 a[64:67], v20 offset:20480
    ds_read_b128 a[68:71], v21 offset:20480
    ds_read_b128 a[72:75], v22 offset:20480
    ds_read_b128 a[76:79], v23 offset:20480
    s_cbranch_vccnz L_rare8
L_ret8:
    s_waitcnt lgkmcnt(4)
    v_mfma_f32_16x16x32_bf16 v[160:163], a[48:51], a[0:3], v[52:55]
    v_mfma_f32_16x16x32_bf16 v[160:163], a[52:55], a[4:7], v[160:163]
    ds_read_b64_tr_b16 a[80:81], v24
    ds_read_b64_tr_b16 a[82:83], v24 offset:4096
    v_add_f32 v13, v13, v16
    v_add_f32 v14, v14, v17
    v_add_f32 v15, v15, v18
    v_mfma_f32_16x16x32_bf16 v[160:163], a[56:59], a[8:11], v[160:163]
    v_mfma_f32_16x16x32_bf16 v[160:163], a[60:63], a[12:15], v[160:163]
    s_cmp_ge_u32 s34, 5
    s_cbranch_scc1 L_nd9
    s_mov_b32 m0, s38
    s_add_u32 s38, s38, 16384
    buffer_load_dwordx4 v2, s[16:19], s36 offen nt lds
    buffer_load_dwordx4 v3, s[16:19], s36 offen offset:1024 nt lds
    buffer_load_dwordx4 v4, s[16:19], s36 offen offset:2048 nt lds
    buffer_load_dwordx4 v5, s[16:19], s36 offen offset:3072 nt lds
    s_add_u32 s36, s36, 16384
    s_and_b32 s38, s38, 0xffff
L_nd9:
    ds_read_b64_tr_b16 a[84:85], v25
    v_mfma_f32_16x16x32_bf16 v[168:171], a[48:51], a[16:19], v[56:59]
    v_mfma_f32_16x16x32_bf16 v[168:171], a[52:55], a[20:23], v[168:171]
    ds_read_b64_tr_b16 a[86:87], v25 offset:4096
    v_mfma_f32_16x16x32_bf16 v[168:171], a[56:59], a[24:27], v[168:171]
    v_mfma_f32_16x16x32_bf16 v[168:171], a[60:63], a[28:31], v[168:171]
    ds_read_b64_tr_b16 a[88:89], v26
    ds_read_b64_tr_b16 a[90:91], v26 offset:4096
    v_mfma_f32_16x16x32_bf16 v[176:179], a[48:51], a[32:35], v[60:63]
    v_mfma_f32_16x16x32_bf16 v[176:179], a[52:55], a[36:39], v[176:179]
    ds_read_b64_tr_b16 a[92:93], v27
    v_exp_f32 v36, v184
    v_exp_f32 v37, v185
    v_mfma_f32_16x16x32_bf16 v[176:179], a[56:59], a[40:43], v[176:179]
    v_mfma_f32_16x16x32_bf16 v[176:179], a[60:63], a[44:47], v[176:179]
    ds_read_b64_tr_b16 a[94:95], v27 offset:4096
    v_exp_f32 v38, v186
    v_cvt_pk_bf16_f32 v220, v36, v37
    v_add_f32 v16, v36, v37
    s_waitcnt lgkmcnt(8)
    v_mfma_f32_16x16x32_bf16 v[164:167], a[64:67], a[0:3], v[52:55]
    v_mfma_f32_16x16x32_bf16 v[164:167], a[68:71], a[4:7], v[164:167]
    ds_read_b64_tr_b16 a[96:97], v28
    ds_read_b64_tr_b16 a[98:99], v28 offset:4096
    v_exp_f32 v39, v187
    v_exp_f32 v40, v188
    v_mfma_f32_16x16x32_bf16 v[164:167], a[72:75], a[8:11], v[164:167]
    v_mfma_f32_16x16x32_bf16 v[164:167], a[76:79], a[12:15], v[164:167]
    ds_read_b64_tr_b16 a[100:101], v29
    v_cvt_pk_bf16_f32 v221, v38, v39
    v_add_f32 v16, v16, v38
    v_exp_f32 v41, v189
    v_mfma_f32_16x16x32_bf16 v[172:175], a[64:67], a[16:19], v[56:59]
    v_mfma_f32_16x16x32_bf16 v[172:175], a[68:71], a[20:23], v[172:175]
    ds_read_b64_tr_b16 a[102:103], v29 offset:4096
    v_add_f32 v16, v16, v39
    v_exp_f32 v36, v190
    v_cvt_pk_bf16_f32 v222, v40, v41
    v_mfma_f32_16x16x32_bf16 v[172:175], a[72:75], a[24:27], v[172:175]
    v_mfma_f32_16x16x32_bf16 v[172:175], a[76:79], a[28:31], v[172:175]
    ds_read_b64_tr_b16 a[104:105], v30
    ds_read_b64_tr_b16 a[106:107], v30 offset:4096
    v_add_f32 v16, v16, v40
    v_exp_f32 v37, v191
    v_mfma_f32_16x16x32_bf16 v[180:183], a[64:67], a[32:35], v[60:63]
    v_mfma_f32_16x16x32_bf16 v[180:183], a[68:71], a[36:39], v[180:183]
    ds_read_b64_tr_b16 a[108:109], v31
    v_add_f32 v16, v16, v41
    v_exp_f32 v38, v192
    v_cvt_pk_bf16_f32 v223, v36, v37
    v_add_f32 v16, v16, v36
    v_mfma_f32_16x16x32_bf16 v[180:183], a[72:75], a[40:43], v[180:183]
    v_mfma_f32_16x16x32_bf16 v[180:183], a[76:79], a[44:47], v[180:183]
    ds_read_b64_tr_b16 a[110:111], v31 offset:4096
    v_exp_f32 v39, v193
    v_add_f32 v16, v16, v37
    s_waitcnt lgkmcnt(8)
    v_mfma_f32_16x16x32_bf16 v[64:67], a[80:83], v[208:211], v[64:67]
    v_exp_f32 v40, v194
    v_mfma_f32_16x16x32_bf16 v[68:71], a[80:83], v[212:215], v[68:71]
    v_cvt_pk_bf16_f32 v224, v38, v39
    v_add_f32 v17, v38, v39
    v_mfma_f32_16x16x32_bf16 v[72:75], a[80:83], v[216:219], v[72:75]
    v_exp_f32 v41, v195
    v_mfma_f32_16x16x32_bf16 v[76:79], a[84:87], v[208:211], v[76:79]
    v_exp_f32 v36, v196
    v_cvt_pk_bf16_f32 v225, v40, v41
    v_add_f32 v17, v17, v40
    v_mfma_f32_16x16x32_bf16 v[80:83], a[84:87], v[212:215], v[80:83]
    v_exp_f32 v37, v197
    v_add_f32 v17, v17, v41
    v_mfma_f32_16x16x32_bf16 v[84:87], a[84:87], v[216:219], v[84:87]
    v_exp_f32 v38, v198
    v_cvt_pk_bf16_f32 v226, v36, v37
    v_mfma_f32_16x16x32_bf16 v[88:91], a[88:91], v[208:211], v[88:91]
    v_add_f32 v17, v17, v36
    v_exp_f32 v39, v199
    v_mfma_f32_16x16x32_bf16 v[92:95], a[88:91], v[212:215], v[92:95]
    v_add_f32 v17, v17, v37
    v_exp_f32 v40, v200
    v_mfma_f32_16x16x32_bf16 v[96:99], a[88:91], v[216:219], v[96:99]
    v_cvt_pk_bf16_f32 v227, v38, v39
    v_add_f32 v17, v17, v38
    v_mfma_f32_16x16x32_bf16 v[100:103], a[92:95], v[208:211], v[100:103]
    v_exp_f32 v41, v201
    v_mfma_f32_16x16x32_bf16 v[104:107], a[92:95], v[212:215], v[104:107]
    ds_read_b128 a[48:51], v20 offset:24576
    v_add_f32 v17, v17, v39
    v_mfma_f32_16x16x32_bf16 v[108:111], a[92:95], v[216:219], v[108:111]
    ds_read_b128 a[52:55], v21 offset:24576
    s_waitcnt lgkmcnt(2)
    v_mfma_f32_16x16x32_bf16 v[112:115], a[96:99], v[208:211], v[112:115]
    ds_read_b128 a[56:59], v22 offset:24576
    v_exp_f32 v36, v202
    v_cvt_pk_bf16_f32 v228, v40, v41
    v_mfma_f32_16x16x32_bf16 v[116:119], a[96:99], v[212:215], v[116:119]
    v_add_f32 v18, v40, v41
    v_exp_f32 v37, v203
    v_mfma_f32_16x16x32_bf16 v[120:123], a[96:99], v[216:219], v[120:123]
    ds_read_b128 a[60:63], v23 offset:24576
    v_exp_f32 v38, v204
    v_mfma_f32_16x16x32_bf16 v[124:127], a[100:103], v[208:211], v[124:127]
    v_cvt_pk_bf16_f32 v229, v36, v37
    v_add_f32 v18, v18, v36
    v_mfma_f32_16x16x32_bf16 v[128:131], a[100:103], v[212:215], v[128:131]
    ds_read_b128 a[64:67], v20 offset:28672
    v_exp_f32 v39, v205
    v_mfma_f32_16x16x32_bf16 v[132:135], a[100:103], v[216:219], v[132:135]
    v_add_f32 v18, v18, v37
    v_exp_f32 v40, v206
    v_mfma_f32_16x16x32_bf16 v[136:139], a[104:107], v[208:211], v[136:139]
    ds_read_b128 a[68:71], v21 offset:28672
    v_cvt_pk_bf16_f32 v230, v38, v39
    v_mfma_f32_16x16x32_bf16 v[140:143], a[104:107], v[212:215], v[140:143]
    v_add_f32 v18, v18, v38
    v_exp_f32 v41, v207
    v_mfma_f32_16x16x32_bf16 v[144:147], a[104:107], v[216:219], v[144:147]
    ds_read_b128 a[72:75], v22 offset:28672
    v_add_f32 v18, v18, v39
    v_add_f32 v18, v18, v40
    v_mfma_f32_16x16x32_bf16 v[148:151], a[108:111], v[208:211], v[148:151]
    v_add_f32 v18, v18, v41
    v_cvt_pk_bf16_f32 v231, v40, v41
    v_mfma_f32_16x16x32_bf16 v[152:155], a[108:111], v[212:215], v[152:155]
    ds_read_b128 a[76:79], v23 offset:28672
    v_max3_f32 v32, v16, v17, v18
    v_cmp_nge_f32 vcc, 0x45800000, v32
    v_mfma_f32_16x16x32_bf16 v[156:159], a[108:111], v[216:219], v[156:159]
    s_cbranch_vccnz L_rare10
L_ret10:
    s_waitcnt lgkmcnt(4)
    v_mfma_f32_16x16x32_bf16 v[184:187], a[48:51], a[0:3], v[52:55]
    v_mfma_f32_16x16x32_bf16 v[184:187], a[52:55], a[4:7], v[184:187]
    ds_read_b64_tr_b16 a[80:81], v24 offset:8192
    ds_read_b64_tr_b16 a[82:83], v24 offset:12288
    v_add_f32 v13, v13, v16
    v_add_f32 v14, v14, v17
    v_add_f32 v15, v15, v18
    v_xor_b32 v20, 0x8000, v20
    v_mfma_f32_16x16x32_bf16 v[184:187], a[56:59], a[8:11], v[184:187]
    v_mfma_f32_16x16x32_bf16 v[184:187], a[60:63], a[12:15], v[184:187]
    s_cmp_ge_u32 s34, 5
    s_cbranch_scc1 L_nd11
    s_add_u32 m0, s39, 65536
    s_add_u32 s39, s39, 16384
    buffer_load_dwordx4 v6, s[20:23], s37 offen nt lds
    buffer_load_dwordx4 v7, s[20:23], s37 offen offset:1024 nt lds
    buffer_load_dwordx4 v6, s[20:23], s37 offen offset:2048 nt lds
    buffer_load_dwordx4 v7, s[20:23], s37 offen offset:3072 nt lds
    s_add_u32 s37, s37, 16384
    s_and_b32 s39, s39, 0xffff
L_nd11:
    ds_read_b64_tr_b16 a[84:85], v25 offset:8192
    v_mfma_f32_16x16x32_bf16 v[192:195], a[48:51], a[16:19], v[56:59]
    v_mfma_f32_16x16x32_bf16 v[192:195], a[52:55], a[20:23], v[192:195]
    ds_read_b64_tr_b16 a[86:87], v25 offset:12288
    v_mfma_f32_16x16x32_bf16 v[192:195], a[56:59], a[24:27], v[192:195]
    v_mfma_f32_16x16x32_bf16 v[192:195], a[60:63], a[28:31], v[192:195]
    ds_read_b64_tr_b16 a[88:89], v26 offset:8192
    ds_read_b64_tr_b16 a[90:91], v26 offset:12288
    v_mfma_f32_16x16x32_bf16 v[200:203], a[48:51], a[32:35], v[60:63]
    v_mfma_f32_16x16x32_bf16 v[200:203], a[52:55], a[36:39], v[200:203]
    ds_read_b64_tr_b16 a[92:93], v27 offset:8192
    v_xor_b32 v21, 0x8000, v21
    v_xor_b32 v22, 0x8000, v22
    v_xor_b32 v23, 0x8000, v23
    v_exp_f32 v36, v160
    v_mfma_f32_16x16x32_bf16 v[200:203], a[56:59], a[40:43], v[200:203]
    v_mfma_f32_16x16x32_bf16 v[200:203], a[60:63], a[44:47], v[200:203]
    ds_read_b64_tr_b16 a[94:95], v27 offset:12288
    v_exp_f32 v37, v161
    v_exp_f32 v38, v162
    s_waitcnt lgkmcnt(8)
    v_mfma_f32_16x16x32_bf16 v[188:191], a[64:67], a[0:3], v[52:55]
    v_mfma_f32_16x16x32_bf16 v[188:191], a[68:71], a[4:7], v[188:191]
    ds_read_b64_tr_b16 a[96:97], v28 offset:8192
    ds_read_b64_tr_b16 a[98:99], v28 offset:12288
    v_cvt_pk_bf16_f32 v208, v36, v37
    v_add_f32 v16, v36, v37
    v_exp_f32 v39, v163
    v_mfma_f32_16x16x32_bf16 v[188:191], a[72:75], a[8:11], v[188:191]
    v_mfma_f32_16x16x32_bf16 v[188:191], a[76:79], a[12:15], v[188:191]
    ds_read_b64_tr_b16 a[100:101], v29 offset:8192
    v_exp_f32 v40, v164
    v_cvt_pk_bf16_f32 v209, v38, v39
    v_add_f32 v16, v16, v38
    v_mfma_f32_16x16x32_bf16 v[196:199], a[64:67], a[16:19], v[56:59]
    v_mfma_f32_16x16x32_bf16 v[196:199], a[68:71], a[20:23], v[196:199]
    ds_read_b64_tr_b16 a[102:103], v29 offset:12288
    v_exp_f32 v41, v165
    v_add_f32 v16, v16, v39
    v_exp_f32 v36, v166
    v_mfma_f32_16x16x32_bf16 v[196:199], a[72:75], a[24:27], v[196:199]
    v_mfma_f32_16x16x32_bf16 v[196:199], a[76:79], a[28:31], v[196:199]
    ds_read_b64_tr_b16 a[104:105], v30 offset:8192
    ds_read_b64_tr_b16 a[106:107], v30 offset:12288
    v_cvt_pk_bf16_f32 v210, v40, v41
    v_add_f32 v16, v16, v40
    v_mfma_f32_16x16x32_bf16 v[204:207], a[64:67], a[32:35], v[60:63]
    v_mfma_f32_16x16x32_bf16 v[204:207], a[68:71], a[36:39], v[204:207]
    ds_read_b64_tr_b16 a[108:109], v31 offset:8192
    v_exp_f32 v37, v167
    v_add_f32 v16, v16, v41
    v_exp_f32 v38, v168
    v_mfma_f32_16x16x32_bf16 v[204:207], a[72:75], a[40:43], v[204:207]
    v_mfma_f32_16x16x32_bf16 v[204:207], a[76:79], a[44:47], v[204:207]
    ds_read_b64_tr_b16 a[110:111], v31 offset:12288
    v_cvt_pk_bf16_f32 v211, v36, v37
    v_add_f32 v16, v16, v36
    v_exp_f32 v39, v169
    s_waitcnt lgkmcnt(8)
    v_mfma_f32_16x16x32_bf16 v[64:67], a[80:83], v[220:223], v[64:67]
    v_add_f32 v16, v16, v37
    v_exp_f32 v40, v170
    v_mfma_f32_16x16x32_bf16 v[68:71], a[80:83], v[224:227], v[68:71]
    v_cvt_pk_bf16_f32 v212, v38, v39
    v_add_f32 v17, v38, v39
    v_mfma_f32_16x16x32_bf16 v[72:75], a[80:83], v[228:231], v[72:75]
    v_exp_f32 v41, v171
    v_mfma_f32_16x16x32_bf16 v[76:79], a[84:87], v[220:223], v[76:79]
    v_exp_f32 v36, v172
    v_cvt_pk_bf16_f32 v213, v40, v41
    v_add_f32 v17, v17, v40
    v_mfma_f32_16x16x32_bf16 v[80:83], a[84:87], v[224:227], v[80:83]
    v_exp_f32 v37, v173
    v_add_f32 v17, v17, v41
    v_mfma_f32_16x16x32_bf16 v[84:87], a[84:87], v[228:231], v[84:87]
    v_exp_f32 v38, v174
    v_cvt_pk_bf16_f32 v214, v36, v37
    v_mfma_f32_16x16x32_bf16 v[88:91], a[88:91], v[220:223], v[88:91]
    v_add_f32 v17, v17, v36
    v_exp_f32 v39, v175
    v_mfma_f32_16x16x32_bf16 v[92:95], a[88:91], v[224:227], v[92:95]
    v_add_f32 v17, v17, v37
    v_exp_f32 v40, v176
    v_mfma_f32_16x16x32_bf16 v[96:99], a[88:91], v[228:231], v[96:99]
    v_cvt_pk_bf16_f32 v215, v38, v39
    v_add_f32 v17, v17, v38
    v_mfma_f32_16x16x32_bf16 v[100:103], a[92:95], v[220:223], v[100:103]
    v_exp_f32 v41, v177
    v_add_f32 v17, v17, v39
    v_mfma_f32_16x16x32_bf16 v[104:107], a[92:95], v[224:227], v[104:107]
    s_waitcnt vmcnt(8) lgkmcnt(0)
    s_barrier
    ds_read_b128 a[48:51], v20
    v_mfma_f32_16x16x32_bf16 v[108:111], a[92:95], v[228:231], v[108:111]
    ds_read_b128 a[52:55], v21
    v_mfma_f32_16x16x32_bf16 v[112:115], a[96:99], v[220:223], v[112:115]
    ds_read_b128 a[56:59], v22
    v_exp_f32 v36, v178
    v_mfma_f32_16x16x32_bf16 v[116:119], a[96:99], v[224:227], v[116:119]
    v_cvt_pk_bf16_f32 v216, v40, v41
    v_add_f32 v18, v40, v41
    v_mfma_f32_16x16x32_bf16 v[120:123], a[96:99], v[228:231], v[120:123]
    ds_read_b128 a[60:63], v23
    v_exp_f32 v37, v179
    v_mfma_f32_16x16x32_bf16 v[124:127], a[100:103], v[220:223], v[124:127]
    v_exp_f32 v38, v180
    v_cvt_pk_bf16_f32 v217, v36, v37
    v_mfma_f32_16x16x32_bf16 v[128:131], a[100:103], v[224:227], v[128:131]
    ds_read_b128 a[64:67], v20 offset:4096
    v_add_f32 v18, v18, v36
    v_mfma_f32_16x16x32_bf16 v[132:135], a[100:103], v[228:231], v[132:135]
    v_exp_f32 v39, v181
    v_add_f32 v18, v18, v37
    v_mfma_f32_16x16x32_bf16 v[136:139], a[104:107], v[220:223], v[136:139]
    ds_read_b128 a[68:71], v21 offset:4096
    v_exp_f32 v40, v182
    v_mfma_f32_16x16x32_bf16 v[140:143], a[104:107], v[224:227], v[140:143]
    v_cvt_pk_bf16_f32 v218, v38, v39
    v_add_f32 v18, v18, v38
    v_mfma_f32_16x16x32_bf16 v[144:147], a[104:107], v[228:231], v[144:147]
    ds_read_b128 a[72:75], v22 offset:4096
    v_exp_f32 v41, v183
    v_add_f32 v18, v18, v39
    v_mfma_f32_16x16x32_bf16 v[148:151], a[108:111], v[220:223], v[148:151]
    v_add_f32 v18, v18, v40
    v_add_f32 v18, v18, v41
    v_cvt_pk_bf16_f32 v219, v40, v41
    v_mfma_f32_16x16x32_bf16 v[152:155], a[108:111], v[224:227], v[152:155]
    ds_read_b128 a[76:79], v23 offset:4096
    v_max3_f32 v32, v16, v17, v18
    v_cmp_nge_f32 vcc, 0x45800000, v32
    v_mfma_f32_16x16x32_bf16 v[156:159], a[108:111], v[228:231], v[156:159]
    s_cbranch_vccnz L_rare12
L_ret12:
    s_mov_b32 s29, 2
.p2align 6
SL_loop:
    s_waitcnt lgkmcnt(4)
    v_mfma_f32_16x16x32_bf16 v[160:163], a[48:51], a[0:3], v[52:55]
    v_mfma_f32_16x16x32_bf16 v[160:163], a[52:55], a[4:7], v[160:163]
    ds_read_b64_tr_b16 a[80:81], v24 offset:16384
    ds_read_b64_tr_b16 a[82:83], v24 offset:20480
    v_add_f32 v13, v13, v16
    v_add_f32 v14, v14, v17
    v_add_f32 v15, v15, v18
    v_mfma_f32_16x16x32_bf16 v[160:163], a[56:59], a[8:11], v[160:163]
    v_mfma_f32_16x16x32_bf16 v[160:163], a[60:63], a[12:15], v[160:163]
    s_mov_b32 m0, s38
    s_add_u32 s38, s38, 16384
    ds_read_b64_tr_b16 a[84:85], v25 offset:16384
    buffer_load_dwordx4 v2, s[16:19], s36 offen nt lds
    v_exp_f32 v36, v184
    v_mfma_f32_16x16x32_bf16 v[168:171], a[48:51], a[16:19], v[56:59]
    v_mfma_f32_16x16x32_bf16 v[168:171], a[52:55], a[20:23], v[168:171]
    ds_read_b64_tr_b16 a[86:87], v25 offset:20480
    buffer_load_dwordx4 v3, s[16:19], s36 offen offset:1024 nt lds
    v_exp_f32 v37, v185
    v_mfma_f32_16x16x32_bf16 v[168:171], a[56:59], a[24:27], v[168:171]
    v_mfma_f32_16x16x32_bf16 v[168:171], a[60:63], a[28:31], v[168:171]
    ds_read_b64_tr_b16 a[88:89], v26 offset:16384
    ds_read_b64_tr_b16 a[90:91], v26 offset:20480
    buffer_load_dwordx4 v4, s[16:19], s36 offen offset:2048 nt lds
    v_exp_f32 v38, v186
    v_cvt_pk_bf16_f32 v220, v36, v37
    v_mfma_f32_16x16x32_bf16 v[176:179], a[48:51], a[32:35], v[60:63]
    v_mfma_f32_16x16x32_bf16 v[176:179], a[52:55], a[36:39], v[176:179]
    ds_read_b64_tr_b16 a[92:93], v27 offset:16384
    buffer_load_dwordx4 v5, s[16:19], s36 offen offset:3072 nt lds
    v_add_f32 v16, v36, v37
    v_exp_f32 v39, v187
    v_mfma_f32_16x16x32_bf16 v[176:179], a[56:59], a[40:43], v[176:179]
    v_mfma_f32_16x16x32_bf16 v[176:179], a[60:63], a[44:47], v[176:179]
    ds_read_b64_tr_b16 a[94:95], v27 offset:20480
    s_add_u32 s36, s36, 16384
    s_and_b32 s38, s38, 0xffff
    s_waitcnt lgkmcnt(8)
    v_mfma_f32_16x16x32_bf16 v[164:167], a[64:67], a[0:3], v[52:55]
    v_mfma_f32_16x16x32_bf16 v[164:167], a[68:71], a[4:7], v[164:167]
    ds_read_b64_tr_b16 a[96:97], v28 offset:16384
    ds_read_b64_tr_b16 a[98:99], v28 offset:20480
    v_exp_f32 v40, v188
    v_cvt_pk_bf16_f32 v221, v38, v39
    v_add_f32 v16, v16, v38
    v_mfma_f32_16x16x32_bf16 v[164:167], a[72:75], a[8:11], v[164:167]
    v_mfma_f32_16x16x32_bf16 v[164:167], a[76:79], a[12:15], v[164:167]
    ds_read_b64_tr_b16 a[100:101], v29 offset:16384
    v_exp_f32 v41, v189
    v_add_f32 v16, v16, v39
    v_exp_f32 v36, v190
    v_mfma_f32_16x16x32_bf16 v[172:175], a[64:67], a[16:19], v[56:59]
    v_mfma_f32_16x16x32_bf16 v[172:175], a[68:71], a[20:23], v[172:175]
    ds_read_b64_tr_b16 a[102:103], v29 offset:20480
    v_cvt_pk_bf16_f32 v222, v40, v41
    v_add_f32 v16, v16, v40
    v_exp_f32 v37, v191
    v_mfma_f32_16x16x32_bf16 v[172:175], a[72:75], a[24:27], v[172:175]
    v_mfma_f32_16x16x32_bf16 v[172:175], a[76:79], a[28:31], v[172:175]
    ds_read_b64_tr_b16 a[104:105], v30 offset:16384
    ds_read_b64_tr_b16 a[106:107], v30 offset:20480
    v_add_f32 v16, v16, v41
    v_exp_f32 v38, v192
    v_mfma_f32_16x16x32_bf16 v[180:183], a[64:67], a[32:35], v[60:63]
    v_mfma_f32_16x16x32_bf16 v[180:183], a[68:71], a[36:39], v[180:183]
    ds_read_b64_tr_b16 a[108:109], v31 offset:16384
    v_cvt_pk_bf16_f32 v223, v36, v37
    v_add_f32 v16, v16, v36
    v_exp_f32 v39, v193
    v_mfma_f32_16x16x32_bf16 v[180:183], a[72:75], a[40:43], v[180:183]
    v_mfma_f32_16x16x32_bf16 v[180:183], a[76:79], a[44:47], v[180:183]
    ds_read_b64_tr_b16 a[110:111], v31 offset:20480
    v_add_f32 v16, v16, v37
    v_exp_f32 v40, v194
    s_waitcnt lgkmcnt(8)
    v_mfma_f32_16x16x32_bf16 v[64:67], a[80:83], v[208:211], v[64:67]
    v_cvt_pk_bf16_f32 v224, v38, v39
    v_add_f32 v17, v38, v39
    v_mfma_f32_16x16x32_bf16 v[68:71], a[80:83], v[212:215], v[68:71]
    v_exp_f32 v41, v195
    v_mfma_f32_16x16x32_bf16 v[72:75], a[80:83], v[216:219], v[72:75]
    v_exp_f32 v36, v196
    v_cvt_pk_bf16_f32 v225, v40, v41
    v_mfma_f32_16x16x32_bf16 v[76:79], a[84:87], v[208:211], v[76:79]
    v_add_f32 v17, v17, v40
    v_exp_f32 v37, v197
    v_mfma_f32_16x16x32_bf16 v[80:83], a[84:87], v[212:215], v[80:83]
    v_add_f32 v17, v17, v41
    v_exp_f32 v38, v198
    v_mfma_f32_16x16x32_bf16 v[84:87], a[84:87], v[216:219], v[84:87]
    v_cvt_pk_bf16_f32 v226, v36, v37
    v_add_f32 v17, v17, v36
    v_mfma_f32_16x16x32_bf16 v[88:91], a[88:91], v[208:211], v[88:91]
    v_exp_f32 v39, v199
    v_add_f32 v17, v17, v37
    v_mfma_f32_16x16x32_bf16 v[92:95], a[88:91], v[212:215], v[92:95]
    v_exp_f32 v40, v200
    v_mfma_f32_16x16x32_bf16 v[96:99], a[88:91], v[216:219], v[96:99]
    v_cvt_pk_bf16_f32 v227, v38, v39
    v_add_f32 v17, v17, v38
    v_mfma_f32_16x16x32_bf16 v[100:103], a[92:95], v[208:211], v[100:103]
    v_exp_f32 v41, v201
    v_add_f32 v17, v17, v39
    v_mfma_f32_16x16x32_bf16 v[104:107], a[92:95], v[212:215], v[104:107]
    ds_read_b128 a[48:51], v20 offset:8192
    v_exp_f32 v36, v202
    v_mfma_f32_16x16x32_bf16 v[108:111], a[92:95], v[216:219], v[108:111]
    ds_read_b128 a[52:55], v21 offset:8192
    v_cvt_pk_bf16_f32 v228, v40, v41
    s_waitcnt lgkmcnt(2)
    v_mfma_f32_16x16x32_bf16 v[112:115], a[96:99], v[208:211], v[112:115]
    ds_read_b128 a[56:59], v22 offset:8192
    v_add_f32 v18, v40, v41
    v_mfma_f32_16x16x32_bf16 v[116:119], a[96:99], v[212:215], v[116:119]
    v_exp_f32 v37, v203
    v_mfma_f32_16x16x32_bf16 v[120:123], a[96:99], v[216:219], v[120:123]
    ds_read_b128 a[60:63], v23 offset:8192
    v_exp_f32 v38, v204
    v_mfma_f32_16x16x32_bf16 v[124:127], a[100:103], v[208:211], v[124:127]
    v_cvt_pk_bf16_f32 v229, v36, v37
    v_add_f32 v18, v18, v36
    v_mfma_f32_16x16x32_bf16 v[128:131], a[100:103], v[212:215], v[128:131]
    ds_read_b128 a[64:67], v20 offset:12288
    v_exp_f32 v39, v205
    v_mfma_f32_16x16x32_bf16 v[132:135], a[100:103], v[216:219], v[132:135]
    v_add_f32 v18, v18, v37
    v_exp_f32 v40, v206
    v_mfma_f32_16x16x32_bf16 v[136:139], a[104:107], v[208:211], v[136:139]
    ds_read_b128 a[68:71], v21 offset:12288
    v_cvt_pk_bf16_f32 v230, v38, v39
    v_add_f32 v18, v18, v38
    v_mfma_f32_16x16x32_bf16 v[140:143], a[104:107], v[212:215], v[140:143]
    v_exp_f32 v41, v207
    v_mfma_f32_16x16x32_bf16 v[144:147], a[104:107], v[216:219], v[144:147]
    ds_read_b128 a[72:75], v22 offset:12288
    v_add_f32 v18, v18, v39
    v_add_f32 v18, v18, v40
    v_mfma_f32_16x16x32_bf16 v[148:151], a[108:111], v[208:211], v[148:151]
    v_add_f32 v18, v18, v41
    v_cvt_pk_bf16_f32 v231, v40, v41
    v_mfma_f32_16x16x32_bf16 v[152:155], a[108:111], v[212:215], v[152:155]
    ds_read_b128 a[76:79], v23 offset:12288
    v_max3_f32 v32, v16, v17, v18
    v_cmp_nge_f32 vcc, 0x45800000, v32
    v_mfma_f32_16x16x32_bf16 v[156:159], a[108:111], v[216:219], v[156:159]
    s_cbranch_vccnz L_rare13
L_ret13:
    s_waitcnt lgkmcnt(4)
    v_mfma_f32_16x16x32_bf16 v[184:187], a[48:51], a[0:3], v[52:55]
    v_mfma_f32_16x16x32_bf16 v[184:187], a[52:55], a[4:7], v[184:187]
    ds_read_b64_tr_b16 a[80:81], v24 offset:24576
    ds_read_b64_tr_b16 a[82:83], v24 offset:28672
    v_add_f32 v13, v13, v16
    v_add_f32 v14, v14, v17
    v_add_f32 v15, v15, v18
    v_mfma_f32_16x16x32_bf16 v[184:187], a[56:59], a[8:11], v[184:187]
    v_mfma_f32_16x16x32_bf16 v[184:187], a[60:63], a[12:15], v[184:187]
    s_add_u32 m0, s39, 65536
    s_add_u32 s39, s39, 16384
    ds_read_b64_tr_b16 a[84:85], v25 offset:24576
    buffer_load_dwordx4 v6, s[20:23], s37 offen nt lds
    v_exp_f32 v36, v160
    v_mfma_f32_16x16x32_bf16 v[192:195], a[48:51], a[16:19], v[56:59]
    v_mfma_f32_16x16x32_bf16 v[192:195], a[52:55], a[20:23], v[192:195]
    ds_read_b64_tr_b16 a[86:87], v25 offset:28672
    buffer_load_dwordx4 v7, s[20:23], s37 offen offset:1024 nt lds
    v_exp_f32 v37, v161
    v_exp_f32 v38, v162
    v_mfma_f32_16x16x32_bf16 v[192:195], a[56:59], a[24:27], v[192:195]
    v_mfma_f32_16x16x32_bf16 v[192:195], a[60:63], a[28:31], v[192:195]
    ds_read_b64_tr_b16 a[88:89], v26 offset:24576
    ds_read_b64_tr_b16 a[90:91], v26 offset:28672
    buffer_load_dwordx4 v6, s[20:23], s37 offen offset:2048 nt lds
    v_cvt_pk_bf16_f32 v208, v36, v37
    v_add_f32 v16, v36, v37
    v_mfma_f32_16x16x32_bf16 v[200:203], a[48:51], a[32:35], v[60:63]
    v_mfma_f32_16x16x32_bf16 v[200:203], a[52:55], a[36:39], v[200:203]
    ds_read_b64_tr_b16 a[92:93], v27 offset:24576
    buffer_load_dwordx4 v7, s[20:23], s37 offen offset:3072 nt lds
    v_exp_f32 v39, v163
    v_exp_f32 v40, v164
    v_mfma_f32_16x16x32_bf16 v[200:203], a[56:59], a[40:43], v[200:203]
    v_mfma_f32_16x16x32_bf16 v[200:203], a[60:63], a[44:47], v[200:203]
    ds_read_b64_tr_b16 a[94:95], v27 offset:28672
    s_add_u32 s37, s37, 16384
    s_and_b32 s39, s39, 0xffff
    v_cvt_pk_bf16_f32 v209, v38, v39
    s_waitcnt lgkmcnt(8)
    v_mfma_f32_16x16x32_bf16 v[188:191], a[64:67], a[0:3], v[52:55]
    v_mfma_f32_16x16x32_bf16 v[188:191], a[68:71], a[4:7], v[188:191]
    ds_read_b64_tr_b16 a[96:97], v28 offset:24576
    ds_read_b64_tr_b16 a[98:99], v28 offset:28672
    v_add_f32 v16, v16, v38
    v_exp_f32 v41, v165
    v_add_f32 v16, v16, v39
    v_mfma_f32_16x16x32_bf16 v[188:191], a[72:75], a[8:11], v[188:191]
    v_mfma_f32_16x16x32_bf16 v[188:191], a[76:79], a[12:15], v[188:191]
    ds_read_b64_tr_b16 a[100:101], v29 offset:24576
    v_exp_f32 v36, v166
    v_cvt_pk_bf16_f32 v210, v40, v41
    v_add_f32 v16, v16, v40
    v_mfma_f32_16x16x32_bf16 v[196:199], a[64:67], a[16:19], v[56:59]
    v_mfma_f32_16x16x32_bf16 v[196:199], a[68:71], a[20:23], v[196:199]
    ds_read_b64_tr_b16 a[102:103], v29 offset:28672
    v_exp_f32 v37, v167
    v_add_f32 v16, v16, v41
    v_exp_f32 v38, v168
    v_mfma_f32_16x16x32_bf16 v[196:199], a[72:75], a[24:27], v[196:199]
    v_mfma_f32_16x16x32_bf16 v[196:199], a[76:79], a[28:31], v[196:199]
    ds_read_b64_tr_b16 a[104:105], v30 offset:24576
    ds_read_b64_tr_b16 a[106:107], v30 offset:28672
    v_cvt_pk_bf16_f32 v211, v36, v37
    v_add_f32 v16, v16, v36
    v_exp_f32 v39, v169
    v_mfma_f32_16x16x32_bf16 v[204:207], a[64:67], a[32:35], v[60:63]
    v_mfma_f32_16x16x32_bf16 v[204:207], a[68:71], a[36:39], v[204:207]
    ds_read_b64_tr_b16 a[108:109], v31 offset:24576
    v_add_f32 v16, v16, v37
    v_exp_f32 v40, v170
    v_cvt_pk_bf16_f32 v212, v38, v39
    v_mfma_f32_16x16x32_bf16 v[204:207], a[72:75], a[40:43], v[204:207]
    v_mfma_f32_16x16x32_bf16 v[204:207], a[76:79], a[44:47], v[204:207]
    ds_read_b64_tr_b16 a[110:111], v31 offset:28672
    v_add_f32 v17, v38, v39
    v_exp_f32 v41, v171
    s_waitcnt lgkmcnt(8)
    v_mfma_f32_16x16x32_bf16 v[64:67], a[80:83], v[220:223], v[64:67]
    v_exp_f32 v36, v172
    v_cvt_pk_bf16_f32 v213, v40, v41
    v_mfma_f32_16x16x32_bf16 v[68:71], a[80:83], v[224:227], v[68:71]
    v_add_f32 v17, v17, v40
    v_exp_f32 v37, v173
    v_mfma_f32_16x16x32_bf16 v[72:75], a[80:83], v[228:231], v[72:75]
    v_add_f32 v17, v17, v41
    v_exp_f32 v38, v174
    v_mfma_f32_16x16x32_bf16 v[76:79], a[84:87], v[220:223], v[76:79]
    v_cvt_pk_bf16_f32 v214, v36, v37
    v_add_f32 v17, v17, v36
    v_mfma_f32_16x16x32_bf16 v[80:83], a[84:87], v[224:227], v[80:83]
    v_exp_f32 v39, v175
    v_add_f32 v17, v17, v37
    v_mfma_f32_16x16x32_bf16 v[84:87], a[84:87], v[228:231], v[84:87]
    v_exp_f32 v40, v176
    v_cvt_pk_bf16_f32 v215, v38, v39
    v_mfma_f32_16x16x32_bf16 v[88:91], a[88:91], v[220:223], v[88:91]
    v_add_f32 v17, v17, v38
    v_xor_b32 v24, 0x8000, v24
    v_xor_b32 v25, 0x8000, v25
    v_mfma_f32_16x16x32_bf16 v[92:95], a[88:91], v[224:227], v[92:95]
    v_xor_b32 v26, 0x8000, v26
    v_xor_b32 v27, 0x8000, v27
    v_xor_b32 v28, 0x8000, v28
    v_mfma_f32_16x16x32_bf16 v[96:99], a[88:91], v[228:231], v[96:99]
    v_xor_b32 v29, 0x8000, v29
    v_xor_b32 v30, 0x8000, v30
    v_xor_b32 v31, 0x8000, v31
    v_mfma_f32_16x16x32_bf16 v[100:103], a[92:95], v[220:223], v[100:103]
    v_exp_f32 v41, v177
    v_add_f32 v17, v17, v39
    v_mfma_f32_16x16x32_bf16 v[104:107], a[92:95], v[224:227], v[104:107]
    s_waitcnt vmcnt(8) lgkmcnt(0)
    s_barrier
    ds_read_b128 a[48:51], v20 offset:16384
    v_mfma_f32_16x16x32_bf16 v[108:111], a[92:95], v[228:231], v[108:111]
    ds_read_b128 a[52:55], v21 offset:16384
    v_mfma_f32_16x16x32_bf16 v[112:115], a[96:99], v[220:223], v[112:115]
    ds_read_b128 a[56:59], v22 offset:16384
    v_exp_f32 v36, v178
    v_mfma_f32_16x16x32_bf16 v[116:119], a[96:99], v[224:227], v[116:119]
    v_cvt_pk_bf16_f32 v216, v40, v41
    v_add_f32 v18, v40, v41
    v_mfma_f32_16x16x32_bf16 v[120:123], a[96:99], v[228:231], v[120:123]
    ds_read_b128 a[60:63], v23 offset:16384
    v_exp_f32 v37, v179
    v_mfma_f32_16x16x32_bf16 v[124:127], a[100:103], v[220:223], v[124:127]
    v_exp_f32 v38, v180
    v_cvt_pk_bf16_f32 v217, v36, v37
    v_mfma_f32_16x16x32_bf16 v[128:131], a[100:103], v[224:227], v[128:131]
    ds_read_b128 a[64:67], v20 offset:20480
    v_add_f32 v18, v18, v36
    v_mfma_f32_16x16x32_bf16 v[132:135], a[100:103], v[228:231], v[132:135]
    v_exp_f32 v39, v181
    v_add_f32 v18, v18, v37
    v_mfma_f32_16x16x32_bf16 v[136:139], a[104:107], v[220:223], v[136:139]
    ds_read_b128 a[68:71], v21 offset:20480
    v_exp_f32 v40, v182
    v_mfma_f32_16x16x32_bf16 v[140:143], a[104:107], v[224:227], v[140:143]
    v_cvt_pk_bf16_f32 v218, v38, v39
    v_add_f32 v18, v18, v38
    v_mfma_f32_16x16x32_bf16 v[144:147], a[104:107], v[228:231], v[144:147]
    ds_read_b128 a[72:75], v22 offset:20480
    v_exp_f32 v41, v183
    v_add_f32 v18, v18, v39
    v_mfma_f32_16x16x32_bf16 v[148:151], a[108:111], v[220:223], v[148:151]
    v_add_f32 v18, v18, v40
    v_add_f32 v18, v18, v41
    v_cvt_pk_bf16_f32 v219, v40, v41
    v_mfma_f32_16x16x32_bf16 v[152:155], a[108:111], v[224:227], v[152:155]
    ds_read_b128 a[76:79], v23 offset:20480
    v_max3_f32 v32, v16, v17, v18
    v_cmp_nge_f32 vcc, 0x45800000, v32
    v_mfma_f32_16x16x32_bf16 v[156:159], a[108:111], v[228:231], v[156:159]
    s_cbranch_vccnz L_rare14
L_ret14:
    s_waitcnt lgkmcnt(4)
    v_mfma_f32_16x16x32_bf16 v[160:163], a[48:51], a[0:3], v[52:55]
    v_mfma_f32_16x16x32_bf16 v[160:163], a[52:55], a[4:7], v[160:163]
    ds_read_b64_tr_b16 a[80:81], v24
    ds_read_b64_tr_b16 a[82:83], v24 offset:4096
    v_add_f32 v13, v13, v16
    v_add_f32 v14, v14, v17
    v_add_f32 v15, v15, v18
    v_mfma_f32_16x16x32_bf16 v[160:163], a[56:59], a[8:11], v[160:163]
    v_mfma_f32_16x16x32_bf16 v[160:163], a[60:63], a[12:15], v[160:163]
    s_mov_b32 m0, s38
    s_add_u32 s38, s38, 16384
    ds_read_b64_tr_b16 a[84:85], v25
    buffer_load_dwordx4 v2, s[16:19], s36 offen nt lds
    v_exp_f32 v36, v184
    v_mfma_f32_16x16x32_bf16 v[168:171], a[48:51], a[16:19], v[56:59]
    v_mfma_f32_16x16x32_bf16 v[168:171], a[52:55], a[20:23], v[168:171]
    ds_read_b64_tr_b16 a[86:87], v25 offset:4096
    buffer_load_dwordx4 v3, s[16:19], s36 offen offset:1024 nt lds
    v_exp_f32 v37, v185
    v_mfma_f32_16x16x32_bf16 v[168:171], a[56:59], a[24:27], v[168:171]
    v_mfma_f32_16x16x32_bf16 v[168:171], a[60:63], a[28:31], v[168:171]
    ds_read_b64_tr_b16 a[88:89], v26
    ds_read_b64_tr_b16 a[90:91], v26 offset:4096
    buffer_load_dwordx4 v4, s[16:19], s36 offen offset:2048 nt lds
    v_exp_f32 v38, v186
    v_cvt_pk_bf16_f32 v220, v36, v37
    v_mfma_f32_16x16x32_bf16 v[176:179], a[48:51], a[32:35], v[60:63]
    v_mfma_f32_16x16x32_bf16 v[176:179], a[52:55], a[36:39], v[176:179]
    ds_read_b64_tr_b16 a[92:93], v27
    buffer_load_dwordx4 v5, s[16:19], s36 offen offset:3072 nt lds
    v_add_f32 v16, v36, v37
    v_exp_f32 v39, v187
    v_mfma_f32_16x16x32_bf16 v[176:179], a[56:59], a[40:43], v[176:179]
    v_mfma_f32_16x16x32_bf16 v[176:179], a[60:63], a[44:47], v[176:179]
    ds_read_b64_tr_b16 a[94:95], v27 offset:4096
    s_add_u32 s36, s36, 16384
    s_and_b32 s38, s38, 0xffff
    s_waitcnt lgkmcnt(8)
    v_mfma_f32_16x16x32_bf16 v[164:167], a[64:67], a[0:3], v[52:55]
    v_mfma_f32_16x16x32_bf16 v[164:167], a[68:71], a[4:7], v[164:167]
    ds_read_b64_tr_b16 a[96:97], v28
    ds_read_b64_tr_b16 a[98:99], v28 offset:4096
    v_exp_f32 v40, v188
    v_cvt_pk_bf16_f32 v221, v38, v39
    v_add_f32 v16, v16, v38
    v_mfma_f32_16x16x32_bf16 v[164:167], a[72:75], a[8:11], v[164:167]
    v_mfma_f32_16x16x32_bf16 v[164:167], a[76:79], a[12:15], v[164:167]
    ds_read_b64_tr_b16 a[100:101], v29
    v_exp_f32 v41, v189
    v_add_f32 v16, v16, v39
    v_exp_f32 v36, v190
    v_mfma_f32_16x16x32_bf16 v[172:175], a[64:67], a[16:19], v[56:59]
    v_mfma_f32_16x16x32_bf16 v[172:175], a[68:71], a[20:23], v[172:175]
    ds_read_b64_tr_b16 a[102:103], v29 offset:4096
    v_cvt_pk_bf16_f32 v222, v40, v41
    v_add_f32 v16, v16, v40
    v_exp_f32 v37, v191
    v_mfma_f32_16x16x32_bf16 v[172:175], a[72:75], a[24:27], v[172:175]
    v_mfma_f32_16x16x32_bf16 v[172:175], a[76:79], a[28:31], v[172:175]
    ds_read_b64_tr_b16 a[104:105], v30
    ds_read_b64_tr_b16 a[106:107], v30 offset:4096
    v_add_f32 v16, v16, v41
    v_exp_f32 v38, v192
    v_mfma_f32_16x16x32_bf16 v[180:183], a[64:67], a[32:35], v[60:63]
    v_mfma_f32_16x16x32_bf16 v[180:183], a[68:71], a[36:39], v[180:183]
    ds_read_b64_tr_b16 a[108:109], v31
    v_cvt_pk_bf16_f32 v223, v36, v37
    v_add_f32 v16, v16, v36
    v_exp_f32 v39, v193
    v_mfma_f32_16x16x32_bf16 v[180:183], a[72:75], a[40:43], v[180:183]
    v_mfma_f32_16x16x32_bf16 v[180:183], a[76:79], a[44:47], v[180:183]
    ds_read_b64_tr_b16 a[110:111], v31 offset:4096
    v_add_f32 v16, v16, v37
    v_exp_f32 v40, v194
    s_waitcnt lgkmcnt(8)
    v_mfma_f32_16x16x32_bf16 v[64:67], a[80:83], v[208:211], v[64:67]
    v_cvt_pk_bf16_f32 v224, v38, v39
    v_add_f32 v17, v38, v39
    v_mfma_f32_16x16x32_bf16 v[68:71], a[80:83], v[212:215], v[68:71]
    v_exp_f32 v41, v195
    v_mfma_f32_16x16x32_bf16 v[72:75], a[80:83], v[216:219], v[72:75]
    v_exp_f32 v36, v196
    v_cvt_pk_bf16_f32 v225, v40, v41
    v_mfma_f32_16x16x32_bf16 v[76:79], a[84:87], v[208:211], v[76:79]
    v_add_f32 v17, v17, v40
    v_exp_f32 v37, v197
    v_mfma_f32_16x16x32_bf16 v[80:83], a[84:87], v[212:215], v[80:83]
    v_add_f32 v17, v17, v41
    v_exp_f32 v38, v198
    v_mfma_f32_16x16x32_bf16 v[84:87], a[84:87], v[216:219], v[84:87]
    v_cvt_pk_bf16_f32 v226, v36, v37
    v_add_f32 v17, v17, v36
    v_mfma_f32_16x16x32_bf16 v[88:91], a[88:91], v[208:211], v[88:91]
    v_exp_f32 v39, v199
    v_add_f32 v17, v17, v37
    v_mfma_f32_16x16x32_bf16 v[92:95], a[88:91], v[212:215], v[92:95]
    v_exp_f32 v40, v200
    v_mfma_f32_16x16x32_bf16 v[96:99], a[88:91], v[216:219], v[96:99]
    v_cvt_pk_bf16_f32 v227, v38, v39
    v_add_f32 v17, v17, v38
    v_mfma_f32_16x16x32_bf16 v[100:103], a[92:95], v[208:211], v[100:103]
    v_exp_f32 v41, v201
    v_add_f32 v17, v17, v39
    v_mfma_f32_16x16x32_bf16 v[104:107], a[92:95], v[212:215], v[104:107]
    ds_read_b128 a[48:51], v20 offset:24576
    v_exp_f32 v36, v202
    v_mfma_f32_16x16x32_bf16 v[108:111], a[92:95], v[216:219], v[108:111]
    ds_read_b128 a[52:55], v21 offset:24576
    v_cvt_pk_bf16_f32 v228, v40, v41
    s_waitcnt lgkmcnt(2)
    v_mfma_f32_16x16x32_bf16 v[112:115], a[96:99], v[208:211], v[112:115]
    ds_read_b128 a[56:59], v22 offset:24576
    v_add_f32 v18, v40, v41
    v_mfma_f32_16x16x32_bf16 v[116:119], a[96:99], v[212:215], v[116:119]
    v_exp_f32 v37, v203
    v_mfma_f32_16x16x32_bf16 v[120:123], a[96:99], v[216:219], v[120:123]
    ds_read_b128 a[60:63], v23 offset:24576
    v_exp_f32 v38, v204
    v_mfma_f32_16x16x32_bf16 v[124:127], a[100:103], v[208:211], v[124:127]
    v_cvt_pk_bf16_f32 v229, v36, v37
    v_add_f32 v18, v18, v36
    v_mfma_f32_16x16x32_bf16 v[128:131], a[100:103], v[212:215], v[128:131]
    ds_read_b128 a[64:67], v20 offset:28672
    v_exp_f32 v39, v205
    v_mfma_f32_16x16x32_bf16 v[132:135], a[100:103], v[216:219], v[132:135]
    v_add_f32 v18, v18, v37
    v_exp_f32 v40, v206
    v_mfma_f32_16x16x32_bf16 v[136:139], a[104:107], v[208:211], v[136:139]
    ds_read_b128 a[68:71], v21 offset:28672
    v_cvt_pk_bf16_f32 v230, v38, v39
    v_add_f32 v18, v18, v38
    v_mfma_f32_16x16x32_bf16 v[140:143], a[104:107], v[212:215], v[140:143]
    v_exp_f32 v41, v207
    v_mfma_f32_16x16x32_bf16 v[144:147], a[104:107], v[216:219], v[144:147]
    ds_read_b128 a[72:75], v22 offset:28672
    v_add_f32 v18, v18, v39
    v_add_f32 v18, v18, v40
    v_mfma_f32_16x16x32_bf16 v[148:151], a[108:111], v[208:211], v[148:151]
    v_add_f32 v18, v18, v41
    v_cvt_pk_bf16_f32 v231, v40, v41
    v_mfma_f32_16x16x32_bf16 v[152:155], a[108:111], v[212:215], v[152:155]
    ds_read_b128 a[76:79], v23 offset:28672
    v_max3_f32 v32, v16, v17, v18
    v_cmp_nge_f32 vcc, 0x45800000, v32
    v_mfma_f32_16x16x32_bf16 v[156:159], a[108:111], v[216:219], v[156:159]
    s_cbranch_vccnz L_rare15
L_ret15:
    s_add_u32 s29, s29, 2
    s_waitcnt lgkmcnt(4)
    v_mfma_f32_16x16x32_bf16 v[184:187], a[48:51], a[0:3], v[52:55]
    v_mfma_f32_16x16x32_bf16 v[184:187], a[52:55], a[4:7], v[184:187]
    ds_read_b64_tr_b16 a[80:81], v24 offset:8192
    ds_read_b64_tr_b16 a[82:83], v24 offset:12288
    v_add_f32 v13, v13, v16
    v_add_f32 v14, v14, v17
    v_add_f32 v15, v15, v18
    v_mfma_f32_16x16x32_bf16 v[184:187], a[56:59], a[8:11], v[184:187]
    v_mfma_f32_16x16x32_bf16 v[184:187], a[60:63], a[12:15], v[184:187]
    s_add_u32 m0, s39, 65536
    s_add_u32 s39, s39, 16384
    ds_read_b64_tr_b16 a[84:85], v25 offset:8192
    buffer_load_dwordx4 v6, s[20:23], s37 offen nt lds
    v_xor_b32 v20, 0x8000, v20
    v_xor_b32 v21, 0x8000, v21
    v_mfma_f32_16x16x32_bf16 v[192:195], a[48:51], a[16:19], v[56:59]
    v_mfma_f32_16x16x32_bf16 v[192:195], a[52:55], a[20:23], v[192:195]
    ds_read_b64_tr_b16 a[86:87], v25 offset:12288
    buffer_load_dwordx4 v7, s[20:23], s37 offen offset:1024 nt lds
    v_xor_b32 v22, 0x8000, v22
    v_xor_b32 v23, 0x8000, v23
    v_exp_f32 v36, v160
    v_mfma_f32_16x16x32_bf16 v[192:195], a[56:59], a[24:27], v[192:195]
    v_mfma_f32_16x16x32_bf16 v[192:195], a[60:63], a[28:31], v[192:195]
    ds_read_b64_tr_b16 a[88:89], v26 offset:8192
    ds_read_b64_tr_b16 a[90:91], v26 offset:12288
    buffer_load_dwordx4 v6, s[20:23], s37 offen offset:2048 nt lds
    v_exp_f32 v37, v161
    v_mfma_f32_16x16x32_bf16 v[200:203], a[48:51], a[32:35], v[60:63]
    v_mfma_f32_16x16x32_bf16 v[200:203], a[52:55], a[36:39], v[200:203]
    ds_read_b64_tr_b16 a[92:93], v27 offset:8192
    buffer_load_dwordx4 v7, s[20:23], s37 offen offset:3072 nt lds
    v_exp_f32 v38, v162
    v_cvt_pk_bf16_f32 v208, v36, v37
    v_mfma_f32_16x16x32_bf16 v[200:203], a[56:59], a[40:43], v[200:203]
    v_mfma_f32_16x16x32_bf16 v[200:203], a[60:63], a[44:47], v[200:203]
    ds_read_b64_tr_b16 a[94:95], v27 offset:12288
    s_add_u32 s37, s37, 16384
    s_and_b32 s39, s39, 0xffff
    v_add_f32 v16, v36, v37
    s_waitcnt lgkmcnt(8)
    v_mfma_f32_16x16x32_bf16 v[188:191], a[64:67], a[0:3], v[52:55]
    v_mfma_f32_16x16x32_bf16 v[188:191], a[68:71], a[4:7], v[188:191]
    ds_read_b64_tr_b16 a[96:97], v28 offset:8192
    ds_read_b64_tr_b16 a[98:99], v28 offset:12288
    v_exp_f32 v39, v163
    v_exp_f32 v40, v164
    v_mfma_f32_16x16x32_bf16 v[188:191], a[72:75], a[8:11], v[188:191]
    v_mfma_f32_16x16x32_bf16 v[188:191], a[76:79], a[12:15], v[188:191]
    ds_read_b64_tr_b16 a[100:101], v29 offset:8192
    v_cvt_pk_bf16_f32 v209, v38, v39
    v_add_f32 v16, v16, v38
    v_exp_f32 v41, v165
    v_mfma_f32_16x16x32_bf16 v[196:199], a[64:67], a[16:19], v[56:59]
    v_mfma_f32_16x16x32_bf16 v[196:199], a[68:71], a[20:23], v[196:199]
    ds_read_b64_tr_b16 a[102:103], v29 offset:12288
    v_add_f32 v16, v16, v39
    v_exp_f32 v36, v166
    v_cvt_pk_bf16_f32 v210, v40, v41
    v_add_f32 v16, v16, v40
    v_mfma_f32_16x16x32_bf16 v[196:199], a[72:75], a[24:27], v[196:199]
    v_mfma_f32_16x16x32_bf16 v[196:199], a[76:79], a[28:31], v[196:199]
    ds_read_b64_tr_b16 a[104:105], v30 offset:8192
    ds_read_b64_tr_b16 a[106:107], v30 offset:12288
    v_exp_f32 v37, v167
    v_add_f32 v16, v16, v41
    v_mfma_f32_16x16x32_bf16 v[204:207], a[64:67], a[32:35], v[60:63]
    v_mfma_f32_16x16x32_bf16 v[204:207], a[68:71], a[36:39], v[204:207]
    ds_read_b64_tr_b16 a[108:109], v31 offset:8192
    v_exp_f32 v38, v168
    v_cvt_pk_bf16_f32 v211, v36, v37
    v_add_f32 v16, v16, v36
    v_mfma_f32_16x16x32_bf16 v[204:207], a[72:75], a[40:43], v[204:207]
    v_mfma_f32_16x16x32_bf16 v[204:207], a[76:79], a[44:47], v[204:207]
    ds_read_b64_tr_b16 a[110:111], v31 offset:12288
    v_exp_f32 v39, v169
    v_add_f32 v16, v16, v37
    s_waitcnt lgkmcnt(8)
    v_mfma_f32_16x16x32_bf16 v[64:67], a[80:83], v[220:223], v[64:67]
    v_exp_f32 v40, v170
    v_cvt_pk_bf16_f32 v212, v38, v39
    v_mfma_f32_16x16x32_bf16 v[68:71], a[80:83], v[224:227], v[68:71]
    v_add_f32 v17, v38, v39
    v_exp_f32 v41, v171
    v_mfma_f32_16x16x32_bf16 v[72:75], a[80:83], v[228:231], v[72:75]
    v_exp_f32 v36, v172
    v_cvt_pk_bf16_f32 v213, v40, v41
    v_mfma_f32_16x16x32_bf16 v[76:79], a[84:87], v[220:223], v[76:79]
    v_add_f32 v17, v17, v40
    v_exp_f32 v37, v173
    v_mfma_f32_16x16x32_bf16 v[80:83], a[84:87], v[224:227], v[80:83]
    v_add_f32 v17, v17, v41
    v_exp_f32 v38, v174
    v_mfma_f32_16x16x32_bf16 v[84:87], a[84:87], v[228:231], v[84:87]
    v_cvt_pk_bf16_f32 v214, v36, v37
    v_add_f32 v17, v17, v36
    v_mfma_f32_16x16x32_bf16 v[88:91], a[88:91], v[220:223], v[88:91]
    v_exp_f32 v39, v175
    v_add_f32 v17, v17, v37
    v_mfma_f32_16x16x32_bf16 v[92:95], a[88:91], v[224:227], v[92:95]
    v_exp_f32 v40, v176
    v_mfma_f32_16x16x32_bf16 v[96:99], a[88:91], v[228:231], v[96:99]
    v_cvt_pk_bf16_f32 v215, v38, v39
    v_add_f32 v17, v17, v38
    v_mfma_f32_16x16x32_bf16 v[100:103], a[92:95], v[220:223], v[100:103]
    v_exp_f32 v41, v177
    v_add_f32 v17, v17, v39
    v_mfma_f32_16x16x32_bf16 v[104:107], a[92:95], v[224:227], v[104:107]
    s_waitcnt vmcnt(8) lgkmcnt(0)
    s_barrier
    ds_read_b128 a[48:51], v20
    v_mfma_f32_16x16x32_bf16 v[108:111], a[92:95], v[228:231], v[108:111]
    ds_read_b128 a[52:55], v21
    v_mfma_f32_16x16x32_bf16 v[112:115], a[96:99], v[220:223], v[112:115]
    ds_read_b128 a[56:59], v22
    v_exp_f32 v36, v178
    v_mfma_f32_16x16x32_bf16 v[116:119], a[96:99], v[224:227], v[116:119]
    v_cvt_pk_bf16_f32 v216, v40, v41
    v_add_f32 v18, v40, v41
    v_mfma_f32_16x16x32_bf16 v[120:123], a[96:99], v[228:231], v[120:123]
    ds_read_b128 a[60:63], v23
    v_exp_f32 v37, v179
    v_mfma_f32_16x16x32_bf16 v[124:127], a[100:103], v[220:223], v[124:127]
    v_exp_f32 v38, v180
    v_cvt_pk_bf16_f32 v217, v36, v37
    v_add_f32 v18, v18, v36
    v_mfma_f32_16x16x32_bf16 v[128:131], a[100:103], v[224:227], v[128:131]
    ds_read_b128 a[64:67], v20 offset:4096
    v_exp_f32 v39, v181
    v_mfma_f32_16x16x32_bf16 v[132:135], a[100:103], v[228:231], v[132:135]
    v_add_f32 v18, v18, v37
    v_exp_f32 v40, v182
    v_mfma_f32_16x16x32_bf16 v[136:139], a[104:107], v[220:223], v[136:139]
    ds_read_b128 a[68:71], v21 offset:4096
    v_cvt_pk_bf16_f32 v218, v38, v39
    v_mfma_f32_16x16x32_bf16 v[140:143], a[104:107], v[224:227], v[140:143]
    v_add_f32 v18, v18, v38
    v_exp_f32 v41, v183
    v_mfma_f32_16x16x32_bf16 v[144:147], a[104:107], v[228:231], v[144:147]
    ds_read_b128 a[72:75], v22 offset:4096
    v_add_f32 v18, v18, v39
    v_add_f32 v18, v18, v40
    v_mfma_f32_16x16x32_bf16 v[148:151], a[108:111], v[220:223], v[148:151]
    v_add_f32 v18, v18, v41
    v_cvt_pk_bf16_f32 v219, v40, v41
    v_mfma_f32_16x16x32_bf16 v[152:155], a[108:111], v[224:227], v[152:155]
    ds_read_b128 a[76:79], v23 offset:4096
    v_max3_f32 v32, v16, v17, v18
    v_cmp_nge_f32 vcc, 0x45800000, v32
    v_mfma_f32_16x16x32_bf16 v[156:159], a[108:111], v[228:231], v[156:159]
    s_cbranch_vccnz L_rare16
L_ret16:
    s_cmp_lt_u32 s29, 16
    s_cbranch_scc1 SL_loop
SL_tail:
    ds_read_b64_tr_b16 a[80:81], v24 offset:16384
    ds_read_b64_tr_b16 a[82:83], v24 offset:20480
    ds_read_b64_tr_b16 a[84:85], v25 offset:16384
    ds_read_b64_tr_b16 a[86:87], v25 offset:20480
    ds_read_b64_tr_b16 a[88:89], v26 offset:16384
    ds_read_b64_tr_b16 a[90:91], v26 offset:20480
    ds_read_b64_tr_b16 a[92:93], v27 offset:16384
    ds_read_b64_tr_b16 a[94:95], v27 offset:20480
    ds_read_b64_tr_b16 a[96:97], v28 offset:16384
    ds_read_b64_tr_b16 a[98:99], v28 offset:20480
    ds_read_b64_tr_b16 a[100:101], v29 offset:16384
    ds_read_b64_tr_b16 a[102:103], v29 offset:20480
    ds_read_b64_tr_b16 a[104:105], v30 offset:16384
    ds_read_b64_tr_b16 a[106:107], v30 offset:20480
    ds_read_b64_tr_b16 a[108:109], v31 offset:16384
    ds_read_b64_tr_b16 a[110:111], v31 offset:20480
    v_add_f32 v13, v13, v16
    v_add_f32 v14, v14, v17
    v_add_f32 v15, v15, v18
    v_add_u32 v20, s44, v243
    v_xor_b32 v21, 64, v20
    v_xor_b32 v22, 128, v20
    v_xor_b32 v23, 192, v20
    v_add_u32 v2, s44, v2
    v_add_u32 v3, s44, v3
    v_add_u32 v4, s44, v4
    v_add_u32 v5, s44, v5
    v_exp_f32 v36, v184
    v_exp_f32 v37, v185
    s_waitcnt lgkmcnt(8)
    v_mfma_f32_16x16x32_bf16 v[64:67], a[80:83], v[208:211], v[64:67]
    ds_read_b64_tr_b16 a[48:49], v24 offset:24576
    ds_read_b64_tr_b16 a[50:51], v24 offset:28672
    v_exp_f32 v38, v186
    v_cvt_pk_bf16_f32 v220, v36, v37
    v_mfma_f32_16x16x32_bf16 v[76:79], a[84:87], v[208:211], v[76:79]
    ds_read_b64_tr_b16 a[52:53], v25 offset:24576
    ds_read_b64_tr_b16 a[54:55], v25 offset:28672
    v_add_f32 v16, v36, v37
    v_exp_f32 v39, v187
    v_mfma_f32_16x16x32_bf16 v[88:91], a[88:91], v[208:211], v[88:91]
    ds_read_b64_tr_b16 a[56:57], v26 offset:24576
    ds_read_b64_tr_b16 a[58:59], v26 offset:28672
    v_exp_f32 v40, v188
    v_cvt_pk_bf16_f32 v221, v38, v39
    v_add_f32 v16, v16, v38
    v_mfma_f32_16x16x32_bf16 v[100:103], a[92:95], v[208:211], v[100:103]
    ds_read_b64_tr_b16 a[60:61], v27 offset:24576
    ds_read_b64_tr_b16 a[62:63], v27 offset:28672
    v_exp_f32 v41, v189
    v_add_f32 v16, v16, v39
    s_waitcnt lgkmcnt(8)
    v_mfma_f32_16x16x32_bf16 v[112:115], a[96:99], v[208:211], v[112:115]
    ds_read_b64_tr_b16 a[64:65], v28 offset:24576
    ds_read_b64_tr_b16 a[66:67], v28 offset:28672
    v_exp_f32 v36, v190
    v_cvt_pk_bf16_f32 v222, v40, v41
    v_add_f32 v16, v16, v40
    v_mfma_f32_16x16x32_bf16 v[124:127], a[100:103], v[208:211], v[124:127]
    ds_read_b64_tr_b16 a[68:69], v29 offset:24576
    ds_read_b64_tr_b16 a[70:71], v29 offset:28672
    v_exp_f32 v37, v191
    v_add_f32 v16, v16, v41
    v_add_f32 v16, v16, v36
    v_add_f32 v16, v16, v37
    v_mfma_f32_16x16x32_bf16 v[136:139], a[104:107], v[208:211], v[136:139]
    ds_read_b64_tr_b16 a[72:73], v30 offset:24576
    ds_read_b64_tr_b16 a[74:75], v30 offset:28672
    v_cvt_pk_bf16_f32 v223, v36, v37
    v_cmp_nge_f32 vcc, 0x45800000, v16
    v_mfma_f32_16x16x32_bf16 v[148:151], a[108:111], v[208:211], v[148:151]
    ds_read_b64_tr_b16 a[76:77], v31 offset:24576
    ds_read_b64_tr_b16 a[78:79], v31 offset:28672
    s_cbranch_vccnz L_rare17
L_ret17:
    v_mfma_f32_16x16x32_bf16 v[68:71], a[80:83], v[212:215], v[68:71]
    v_add_f32 v13, v13, v16
    v_exp_f32 v36, v192
    v_mfma_f32_16x16x32_bf16 v[80:83], a[84:87], v[212:215], v[80:83]
    v_exp_f32 v37, v193
    v_mfma_f32_16x16x32_bf16 v[92:95], a[88:91], v[212:215], v[92:95]
    v_exp_f32 v38, v194
    v_cvt_pk_bf16_f32 v224, v36, v37
    v_mfma_f32_16x16x32_bf16 v[104:107], a[92:95], v[212:215], v[104:107]
    v_mov_b32 v32, v13
    v_add_f32 v17, v36, v37
    v_mfma_f32_16x16x32_bf16 v[116:119], a[96:99], v[212:215], v[116:119]
    v_exp_f32 v39, v195
    v_permlane16_swap_b32 v13, v32
    v_mfma_f32_16x16x32_bf16 v[128:131], a[100:103], v[212:215], v[128:131]
    v_exp_f32 v40, v196
    v_add_f32 v13, v13, v32
    v_mfma_f32_16x16x32_bf16 v[140:143], a[104:107], v[212:215], v[140:143]
    v_mov_b32 v32, v13
    v_cvt_pk_bf16_f32 v225, v38, v39
    v_mfma_f32_16x16x32_bf16 v[152:155], a[108:111], v[212:215], v[152:155]
    v_add_f32 v17, v17, v38
    v_permlane32_swap_b32 v13, v32
    s_waitcnt lgkmcnt(8)
    v_mfma_f32_16x16x32_bf16 v[64:67], a[48:51], v[220:223], v[64:67]
    v_exp_f32 v41, v197
    v_mfma_f32_16x16x32_bf16 v[76:79], a[52:55], v[220:223], v[76:79]
    v_add_f32 v13, v13, v32
    v_rcp_f32 v232, v13
    v_mfma_f32_16x16x32_bf16 v[88:91], a[56:59], v[220:223], v[88:91]
    v_add_f32 v17, v17, v39
    v_exp_f32 v36, v198
    v_mfma_f32_16x16x32_bf16 v[100:103], a[60:63], v[220:223], v[100:103]
    v_cvt_pk_bf16_f32 v226, v40, v41
    s_waitcnt lgkmcnt(0)
    v_mfma_f32_16x16x32_bf16 v[112:115], a[64:67], v[220:223], v[112:115]
    v_add_f32 v17, v17, v40
    v_exp_f32 v37, v199
    v_mfma_f32_16x16x32_bf16 v[124:127], a[68:71], v[220:223], v[124:127]
    v_add_f32 v17, v17, v41
    v_add_f32 v17, v17, v36
    v_mfma_f32_16x16x32_bf16 v[136:139], a[72:75], v[220:223], v[136:139]
    v_add_f32 v17, v17, v37
    v_cvt_pk_bf16_f32 v227, v36, v37
    v_cmp_nge_f32 vcc, 0x45800000, v17
    v_mfma_f32_16x16x32_bf16 v[148:151], a[76:79], v[220:223], v[148:151]
    s_cbranch_vccnz L_rare18
L_ret18:
    v_mfma_f32_16x16x32_bf16 v[72:75], a[80:83], v[216:219], v[72:75]
    v_add_f32 v14, v14, v17
    v_exp_f32 v36, v200
    v_exp_f32 v37, v201
    v_mfma_f32_16x16x32_bf16 v[84:87], a[84:87], v[216:219], v[84:87]
    v_exp_f32 v38, v202
    v_cvt_pk_bf16_f32 v228, v36, v37
    v_mov_b32 v33, v14
    v_add_f32 v18, v36, v37
    v_mfma_f32_16x16x32_bf16 v[96:99], a[88:91], v[216:219], v[96:99]
    v_exp_f32 v39, v203
    v_permlane16_swap_b32 v14, v33
    v_exp_f32 v40, v204
    v_mfma_f32_16x16x32_bf16 v[108:111], a[92:95], v[216:219], v[108:111]
    v_add_f32 v14, v14, v33
    v_mov_b32 v33, v14
    v_cvt_pk_bf16_f32 v229, v38, v39
    v_add_f32 v18, v18, v38
    v_permlane32_swap_b32 v14, v33
    v_mfma_f32_16x16x32_bf16 v[120:123], a[96:99], v[216:219], v[120:123]
    v_exp_f32 v41, v205
    v_add_f32 v14, v14, v33
    v_rcp_f32 v234, v14
    v_add_f32 v18, v18, v39
    v_mfma_f32_16x16x32_bf16 v[132:135], a[100:103], v[216:219], v[132:135]
    v_exp_f32 v36, v206
    v_cvt_pk_bf16_f32 v230, v40, v41
    v_add_f32 v18, v18, v40
    v_mfma_f32_16x16x32_bf16 v[144:147], a[104:107], v[216:219], v[144:147]
    v_exp_f32 v37, v207
    v_add_f32 v18, v18, v41
    v_add_f32 v18, v18, v36
    v_add_f32 v18, v18, v37
    v_cvt_pk_bf16_f32 v231, v36, v37
    v_cmp_nge_f32 vcc, 0x45800000, v18
    v_mfma_f32_16x16x32_bf16 v[156:159], a[108:111], v[216:219], v[156:159]
    s_cbranch_vccnz L_rare19
L_ret19:
    v_mfma_f32_16x16x32_bf16 v[68:71], a[48:51], v[224:227], v[68:71]
    v_add_f32 v15, v15, v18
    v_mul_f32 v64, v232, v64
    v_mul_f32 v65, v232, v65
    v_mov_b32 v34, v15
    v_mfma_f32_16x16x32_bf16 v[80:83], a[52:55], v[224:227], v[80:83]
    v_mul_f32 v66, v232, v66
    v_mul_f32 v67, v232, v67
    v_permlane16_swap_b32 v15, v34
    v_mul_f32 v76, v232, v76
    v_add_f32 v15, v15, v34
    v_mfma_f32_16x16x32_bf16 v[92:95], a[56:59], v[224:227], v[92:95]
    v_mov_b32 v34, v15
    v_mul_f32 v77, v232, v77
    v_mul_f32 v78, v232, v78
    v_permlane32_swap_b32 v15, v34
    v_mul_f32 v79, v232, v79
    v_mfma_f32_16x16x32_bf16 v[104:107], a[60:63], v[224:227], v[104:107]
    v_add_f32 v15, v15, v34
    v_rcp_f32 v244, v15
    v_cvt_pk_bf16_f32 v160, v64, v65
    v_cvt_pk_bf16_f32 v161, v66, v67
    v_mfma_f32_16x16x32_bf16 v[116:119], a[64:67], v[224:227], v[116:119]
    v_cvt_pk_bf16_f32 v162, v76, v77
    v_cvt_pk_bf16_f32 v163, v78, v79
    v_mul_f32 v88, v232, v88
    v_mul_f32 v89, v232, v89
    v_permlane16_swap_b32 v160, v162
    v_mfma_f32_16x16x32_bf16 v[128:131], a[68:71], v[224:227], v[128:131]
    v_permlane16_swap_b32 v161, v163
    v_mul_f32 v90, v232, v90
    ds_write_b128 v20, v[160:163] offset:0
    v_mul_f32 v91, v232, v91
    v_mfma_f32_16x16x32_bf16 v[140:143], a[72:75], v[224:227], v[140:143]
    v_mul_f32 v100, v232, v100
    v_mul_f32 v101, v232, v101
    v_mul_f32 v102, v232, v102
    v_mul_f32 v103, v232, v103
    v_cvt_pk_bf16_f32 v164, v88, v89
    v_mfma_f32_16x16x32_bf16 v[152:155], a[76:79], v[224:227], v[152:155]
    v_cvt_pk_bf16_f32 v165, v90, v91
    v_cvt_pk_bf16_f32 v166, v100, v101
    v_cvt_pk_bf16_f32 v167, v102, v103
    v_mul_f32 v112, v232, v112
    v_mul_f32 v113, v232, v113
    v_mfma_f32_16x16x32_bf16 v[72:75], a[48:51], v[228:231], v[72:75]
    v_permlane16_swap_b32 v164, v166
    v_permlane16_swap_b32 v165, v167
    v_mul_f32 v114, v232, v114
    ds_write_b128 v21, v[164:167] offset:0
    v_mul_f32 v115, v232, v115
    v_mfma_f32_16x16x32_bf16 v[84:87], a[52:55], v[228:231], v[84:87]
    v_mul_f32 v124, v232, v124
    v_mul_f32 v125, v232, v125
    v_mul_f32 v126, v232, v126
    v_mul_f32 v127, v232, v127
    v_cvt_pk_bf16_f32 v168, v112, v113
    v_mfma_f32_16x16x32_bf16 v[96:99], a[56:59], v[228:231], v[96:99]
    v_cvt_pk_bf16_f32 v169, v114, v115
    v_cvt_pk_bf16_f32 v170, v124, v125
    v_cvt_pk_bf16_f32 v171, v126, v127
    v_mul_f32 v136, v232, v136
    v_mfma_f32_16x16x32_bf16 v[108:111], a[60:63], v[228:231], v[108:111]
    v_mul_f32 v137, v232, v137
    v_permlane16_swap_b32 v168, v170
    v_permlane16_swap_b32 v169, v171
    v_mul_f32 v138, v232, v138
    ds_write_b128 v22, v[168:171] offset:0
    v_mfma_f32_16x16x32_bf16 v[120:123], a[64:67], v[228:231], v[120:123]
    v_mul_f32 v139, v232, v139
    v_mul_f32 v148, v232, v148
    v_mul_f32 v149, v232, v149
    v_mul_f32 v150, v232, v150
    v_mul_f32 v151, v232, v151
    v_mfma_f32_16x16x32_bf16 v[132:135], a[68:71], v[228:231], v[132:135]
    v_cvt_pk_bf16_f32 v172, v136, v137
    v_cvt_pk_bf16_f32 v173, v138, v139
    v_cvt_pk_bf16_f32 v174, v148, v149
    v_cvt_pk_bf16_f32 v175, v150, v151
    s_nop 0
    v_mfma_f32_16x16x32_bf16 v[144:147], a[72:75], v[228:231], v[144:147]
    s_nop 0
    v_permlane16_swap_b32 v172, v174
    v_permlane16_swap_b32 v173, v175
    s_nop 0
    ds_write_b128 v23, v[172:175] offset:0
    v_mfma_f32_16x16x32_bf16 v[156:159], a[76:79], v[228:231], v[156:159]
    v_mul_f32 v68, v234, v68
    v_mul_f32 v69, v234, v69
    v_mul_f32 v70, v234, v70
    v_mul_f32 v71, v234, v71
    v_mul_f32 v80, v234, v80
    v_mul_f32 v81, v234, v81
    s_waitcnt lgkmcnt(0)
    ds_read_b128 v[184:187], v2 offset:0
    ds_read_b128 v[188:191], v3 offset:1024
    ds_read_b128 v[192:195], v4 offset:2048
    ds_read_b128 v[196:199], v5 offset:3072
    v_mul_f32 v82, v234, v82
    v_mul_f32 v83, v234, v83
    v_cvt_pk_bf16_f32 v208, v68, v69
    v_cvt_pk_bf16_f32 v209, v70, v71
    v_cvt_pk_bf16_f32 v210, v80, v81
    v_cvt_pk_bf16_f32 v211, v82, v83
    v_mul_f32 v92, v234, v92
    v_mul_f32 v93, v234, v93
    v_permlane16_swap_b32 v208, v210
    v_permlane16_swap_b32 v209, v211
    v_mul_f32 v94, v234, v94
    ds_write_b128 v20, v[208:211] offset:4096
    s_waitcnt lgkmcnt(4)
    buffer_store_dwordx4 v[184:187], v238, s[24:27], s47 offen nt
    v_mul_f32 v95, v234, v95
    v_mul_f32 v104, v234, v104
    v_mul_f32 v105, v234, v105
    v_mul_f32 v106, v234, v106
    v_mul_f32 v107, v234, v107
    v_cvt_pk_bf16_f32 v212, v92, v93
    v_cvt_pk_bf16_f32 v213, v94, v95
    v_cvt_pk_bf16_f32 v214, v104, v105
    v_cvt_pk_bf16_f32 v215, v106, v107
    s_waitcnt lgkmcnt(3)
    buffer_store_dwordx4 v[188:191], v238, s[24:27], s47 offen offset:1024 nt
    v_mul_f32 v116, v234, v116
    v_mul_f32 v117, v234, v117
    v_permlane16_swap_b32 v212, v214
    v_permlane16_swap_b32 v213, v215
    v_mul_f32 v118, v234, v118
    ds_write_b128 v21, v[212:215] offset:4096
    v_mul_f32 v119, v234, v119
    v_mul_f32 v128, v234, v128
    v_mul_f32 v129, v234, v129
    s_waitcnt lgkmcnt(3)
    buffer_store_dwordx4 v[192:195], v238, s[24:27], s47 offen offset:2048 nt
    v_mul_f32 v130, v234, v130
    v_mul_f32 v131, v234, v131
    v_cvt_pk_bf16_f32 v216, v116, v117
    v_cvt_pk_bf16_f32 v217, v118, v119
    v_cvt_pk_bf16_f32 v218, v128, v129
    v_cvt_pk_bf16_f32 v219, v130, v131
    v_mul_f32 v140, v234, v140
    v_mul_f32 v141, v234, v141
    v_permlane16_swap_b32 v216, v218
    s_waitcnt lgkmcnt(2)
    buffer_store_dwordx4 v[196:199], v238, s[24:27], s47 offen offset:3072 nt
    v_permlane16_swap_b32 v217, v219
    v_mul_f32 v142, v234, v142
    ds_write_b128 v22, v[216:219] offset:4096
    v_mul_f32 v143, v234, v143
    v_mul_f32 v152, v234, v152
    v_mul_f32 v153, v234, v153
    v_mul_f32 v154, v234, v154
    v_mul_f32 v155, v234, v155
    v_cvt_pk_bf16_f32 v220, v140, v141
    v_cvt_pk_bf16_f32 v221, v142, v143
    v_cvt_pk_bf16_f32 v222, v152, v153
    v_cvt_pk_bf16_f32 v223, v154, v155
    s_nop 0
    s_nop 0
    v_permlane16_swap_b32 v220, v222
    v_permlane16_swap_b32 v221, v223
    s_nop 0
    ds_write_b128 v23, v[220:223] offset:4096
    v_mul_f32 v72, v244, v72
    v_mul_f32 v73, v244, v73
    v_mul_f32 v74, v244, v74
    v_mul_f32 v75, v244, v75
    v_mul_f32 v84, v244, v84
    v_mul_f32 v85, v244, v85
    s_waitcnt lgkmcnt(0)
    ds_read_b128 v[48:51], v2 offset:4096
    ds_read_b128 v[52:55], v3 offset:5120
    ds_read_b128 v[56:59], v4 offset:6144
    ds_read_b128 v[60:63], v5 offset:7168
    v_mul_f32 v86, v244, v86
    v_mul_f32 v87, v244, v87
    v_cvt_pk_bf16_f32 v160, v72, v73
    v_cvt_pk_bf16_f32 v161, v74, v75
    v_cvt_pk_bf16_f32 v162, v84, v85
    v_cvt_pk_bf16_f32 v163, v86, v87
    v_mul_f32 v96, v244, v96
    v_mul_f32 v97, v244, v97
    v_permlane16_swap_b32 v160, v162
    v_permlane16_swap_b32 v161, v163
    v_mul_f32 v98, v244, v98
    ds_write_b128 v20, v[160:163] offset:8192
    s_waitcnt lgkmcnt(4)
    buffer_store_dwordx4 v[48:51], v238, s[24:27], s48 offen nt
    v_mul_f32 v99, v244, v99
    v_mul_f32 v108, v244, v108
    v_mul_f32 v109, v244, v109
    v_mul_f32 v110, v244, v110
    v_mul_f32 v111, v244, v111
    v_cvt_pk_bf16_f32 v164, v96, v97
    v_cvt_pk_bf16_f32 v165, v98, v99
    v_cvt_pk_bf16_f32 v166, v108, v109
    v_cvt_pk_bf16_f32 v167, v110, v111
    s_waitcnt lgkmcnt(3)
    buffer_store_dwordx4 v[52:55], v238, s[24:27], s48 offen offset:1024 nt
    v_mul_f32 v120, v244, v120
    v_mul_f32 v121, v244, v121
    v_permlane16_swap_b32 v164, v166
    v_permlane16_swap_b32 v165, v167
    v_mul_f32 v122, v244, v122
    ds_write_b128 v21, v[164:167] offset:8192
    v_mul_f32 v123, v244, v123
    v_mul_f32 v132, v244, v132
    v_mul_f32 v133, v244, v133
    s_waitcnt lgkmcnt(3)
    buffer_store_dwordx4 v[56:59], v238, s[24:27], s48 offen offset:2048 nt
    v_mul_f32 v134, v244, v134
    v_mul_f32 v135, v244, v135
    v_cvt_pk_bf16_f32 v168, v120, v121
    v_cvt_pk_bf16_f32 v169, v122, v123
    v_cvt_pk_bf16_f32 v170, v132, v133
    v_cvt_pk_bf16_f32 v171, v134, v135
    v_mul_f32 v144, v244, v144
    v_mul_f32 v145, v244, v145
    v_permlane16_swap_b32 v168, v170
    s_waitcnt lgkmcnt(2)
    buffer_store_dwordx4 v[60:63], v238, s[24:27], s48 offen offset:3072 nt
    v_permlane16_swap_b32 v169, v171
    v_mul_f32 v146, v244, v146
    ds_write_b128 v22, v[168:171] offset:8192
    v_mul_f32 v147, v244, v147
    v_mul_f32 v156, v244, v156
    v_mul_f32 v157, v244, v157
    v_mul_f32 v158, v244, v158
    v_mul_f32 v159, v244, v159
    v_cvt_pk_bf16_f32 v172, v144, v145
    v_cvt_pk_bf16_f32 v173, v146, v147
    v_cvt_pk_bf16_f32 v174, v156, v157
    v_cvt_pk_bf16_f32 v175, v158, v159
    s_nop 0
    s_nop 0
    v_permlane16_swap_b32 v172, v174
    v_permlane16_swap_b32 v173, v175
    s_nop 0
    ds_write_b128 v23, v[172:175] offset:8192
    s_waitcnt lgkmcnt(0)
    ds_read_b128 v[184:187], v2 offset:8192
    ds_read_b128 v[188:191], v3 offset:9216
    ds_read_b128 v[192:195], v4 offset:10240
    ds_read_b128 v[196:199], v5 offset:11264
    s_waitcnt lgkmcnt(3)
    buffer_store_dwordx4 v[184:187], v238, s[24:27], s49 offen nt
    s_waitcnt lgkmcnt(2)
    buffer_store_dwordx4 v[188:191], v238, s[24:27], s49 offen offset:1024 nt
    s_waitcnt lgkmcnt(1)
    buffer_store_dwordx4 v[192:195], v238, s[24:27], s49 offen offset:2048 nt
    s_waitcnt lgkmcnt(0)
    buffer_store_dwordx4 v[196:199], v238, s[24:27], s49 offen offset:3072 nt
    s_endpgm
L_end:
    s_endpgm
L_rare4:
    s_nop 7
    v_max3_f32 v48, v184, v185, v186
    v_max3_f32 v49, v187, v188, v189
    v_max3_f32 v48, v48, v190, v191
    v_max_f32 v48, v48, v49
    v_mov_b32 v49, v48
    s_nop 1
    v_permlane16_swap_b32 v48, v49
    s_nop 1
    v_max_f32 v48, v48, v49
    v_mov_b32 v49, v48
    s_nop 1
    v_permlane32_swap_b32 v48, v49
    s_nop 1
    v_max_f32 v48, v48, v49
    v_max_f32 v42, 0, v48
    v_exp_f32 v45, -v42
    v_sub_f32 v10, v10, v42
    v_mov_b32 v52, v10
    v_mov_b32 v53, v10
    v_mov_b32 v54, v10
    v_mov_b32 v55, v10
    v_sub_f32 v184, v184, v42
    v_sub_f32 v185, v185, v42
    v_sub_f32 v186, v186, v42
    v_sub_f32 v187, v187, v42
    v_sub_f32 v188, v188, v42
    v_sub_f32 v189, v189, v42
    v_sub_f32 v190, v190, v42
    v_sub_f32 v191, v191, v42
    v_mul_f32 v13, v45, v13
    v_mul_f32 v64, v45, v64
    v_mul_f32 v65, v45, v65
    v_mul_f32 v66, v45, v66
    v_mul_f32 v67, v45, v67
    v_mul_f32 v76, v45, v76
    v_mul_f32 v77, v45, v77
    v_mul_f32 v78, v45, v78
    v_mul_f32 v79, v45, v79
    v_mul_f32 v88, v45, v88
    v_mul_f32 v89, v45, v89
    v_mul_f32 v90, v45, v90
    v_mul_f32 v91, v45, v91
    v_mul_f32 v100, v45, v100
    v_mul_f32 v101, v45, v101
    v_mul_f32 v102, v45, v102
    v_mul_f32 v103, v45, v103
    v_mul_f32 v112, v45, v112
    v_mul_f32 v113, v45, v113
    v_mul_f32 v114, v45, v114
    v_mul_f32 v115, v45, v115
    v_mul_f32 v124, v45, v124
    v_mul_f32 v125, v45, v125
    v_mul_f32 v126, v45, v126
    v_mul_f32 v127, v45, v127
    v_mul_f32 v136, v45, v136
    v_mul_f32 v137, v45, v137
    v_mul_f32 v138, v45, v138
    v_mul_f32 v139, v45, v139
    v_mul_f32 v148, v45, v148
    v_mul_f32 v149, v45, v149
    v_mul_f32 v150, v45, v150
    v_mul_f32 v151, v45, v151
    v_exp_f32 v36, v184
    v_exp_f32 v37, v185
    v_exp_f32 v38, v186
    v_cvt_pk_bf16_f32 v220, v36, v37
    v_add_f32 v16, v36, v37
    v_exp_f32 v39, v187
    v_exp_f32 v40, v188
    v_cvt_pk_bf16_f32 v221, v38, v39
    v_add_f32 v16, v16, v38
    v_exp_f32 v41, v189
    v_add_f32 v16, v16, v39
    v_exp_f32 v36, v190
    v_cvt_pk_bf16_f32 v222, v40, v41
    v_add_f32 v16, v16, v40
    v_exp_f32 v37, v191
    v_add_f32 v16, v16, v41
    v_add_f32 v16, v16, v36
    v_add_f32 v16, v16, v37
    v_cvt_pk_bf16_f32 v223, v36, v37
    s_nop 1
    s_branch L_ret4
L_rare5:
    s_nop 7
    v_max3_f32 v48, v192, v193, v194
    v_max3_f32 v49, v195, v196, v197
    v_max3_f32 v48, v48, v198, v199
    v_max_f32 v48, v48, v49
    v_mov_b32 v49, v48
    s_nop 1
    v_permlane16_swap_b32 v48, v49
    s_nop 1
    v_max_f32 v48, v48, v49
    v_mov_b32 v49, v48
    s_nop 1
    v_permlane32_swap_b32 v48, v49
    s_nop 1
    v_max_f32 v48, v48, v49
    v_max_f32 v43, 0, v48
    v_exp_f32 v46, -v43
    v_sub_f32 v11, v11, v43
    v_mov_b32 v56, v11
    v_mov_b32 v57, v11
    v_mov_b32 v58, v11
    v_mov_b32 v59, v11
    v_sub_f32 v192, v192, v43
    v_sub_f32 v193, v193, v43
    v_sub_f32 v194, v194, v43
    v_sub_f32 v195, v195, v43
    v_sub_f32 v196, v196, v43
    v_sub_f32 v197, v197, v43
    v_sub_f32 v198, v198, v43
    v_sub_f32 v199, v199, v43
    v_mul_f32 v14, v46, v14
    v_mul_f32 v68, v46, v68
    v_mul_f32 v69, v46, v69
    v_mul_f32 v70, v46, v70
    v_mul_f32 v71, v46, v71
    v_mul_f32 v80, v46, v80
    v_mul_f32 v81, v46, v81
    v_mul_f32 v82, v46, v82
    v_mul_f32 v83, v46, v83
    v_mul_f32 v92, v46, v92
    v_mul_f32 v93, v46, v93
    v_mul_f32 v94, v46, v94
    v_mul_f32 v95, v46, v95
    v_mul_f32 v104, v46, v104
    v_mul_f32 v105, v46, v105
    v_mul_f32 v106, v46, v106
    v_mul_f32 v107, v46, v107
    v_mul_f32 v116, v46, v116
    v_mul_f32 v117, v46, v117
    v_mul_f32 v118, v46, v118
    v_mul_f32 v119, v46, v119
    v_mul_f32 v128, v46, v128
    v_mul_f32 v129, v46, v129
    v_mul_f32 v130, v46, v130
    v_mul_f32 v131, v46, v131
    v_mul_f32 v140, v46, v140
    v_mul_f32 v141, v46, v141
    v_mul_f32 v142, v46, v142
    v_mul_f32 v143, v46, v143
    v_mul_f32 v152, v46, v152
    v_mul_f32 v153, v46, v153
    v_mul_f32 v154, v46, v154
    v_mul_f32 v155, v46, v155
    v_exp_f32 v36, v192
    v_exp_f32 v37, v193
    v_exp_f32 v38, v194
    v_cvt_pk_bf16_f32 v224, v36, v37
    v_add_f32 v17, v36, v37
    v_exp_f32 v39, v195
    v_exp_f32 v40, v196
    v_cvt_pk_bf16_f32 v225, v38, v39
    v_add_f32 v17, v17, v38
    v_exp_f32 v41, v197
    v_add_f32 v17, v17, v39
    v_exp_f32 v36, v198
    v_cvt_pk_bf16_f32 v226, v40, v41
    v_add_f32 v17, v17, v40
    v_exp_f32 v37, v199
    v_add_f32 v17, v17, v41
    v_add_f32 v17, v17, v36
    v_add_f32 v17, v17, v37
    v_cvt_pk_bf16_f32 v227, v36, v37
    s_nop 1
    s_branch L_ret5
L_rare6:
    s_nop 7
    v_max3_f32 v48, v200, v201, v202
    v_max3_f32 v49, v203, v204, v205
    v_max3_f32 v48, v48, v206, v207
    v_max_f32 v48, v48, v49
    v_mov_b32 v49, v48
    s_nop 1
    v_permlane16_swap_b32 v48, v49
    s_nop 1
    v_max_f32 v48, v48, v49
    v_mov_b32 v49, v48
    s_nop 1
    v_permlane32_swap_b32 v48, v49
    s_nop 1
    v_max_f32 v48, v48, v49
    v_max_f32 v44, 0, v48
    v_exp_f32 v47, -v44
    v_sub_f32 v12, v12, v44
    v_mov_b32 v60, v12
    v_mov_b32 v61, v12
    v_mov_b32 v62, v12
    v_mov_b32 v63, v12
    v_sub_f32 v200, v200, v44
    v_sub_f32 v201, v201, v44
    v_sub_f32 v202, v202, v44
    v_sub_f32 v203, v203, v44
    v_sub_f32 v204, v204, v44
    v_sub_f32 v205, v205, v44
    v_sub_f32 v206, v206, v44
    v_sub_f32 v207, v207, v44
    v_mul_f32 v15, v47, v15
    v_mul_f32 v72, v47, v72
    v_mul_f32 v73, v47, v73
    v_mul_f32 v74, v47, v74
    v_mul_f32 v75, v47, v75
    v_mul_f32 v84, v47, v84
    v_mul_f32 v85, v47, v85
    v_mul_f32 v86, v47, v86
    v_mul_f32 v87, v47, v87
    v_mul_f32 v96, v47, v96
    v_mul_f32 v97, v47, v97
    v_mul_f32 v98, v47, v98
    v_mul_f32 v99, v47, v99
    v_mul_f32 v108, v47, v108
    v_mul_f32 v109, v47, v109
    v_mul_f32 v110, v47, v110
    v_mul_f32 v111, v47, v111
    v_mul_f32 v120, v47, v120
    v_mul_f32 v121, v47, v121
    v_mul_f32 v122, v47, v122
    v_mul_f32 v123, v47, v123
    v_mul_f32 v132, v47, v132
    v_mul_f32 v133, v47, v133
    v_mul_f32 v134, v47, v134
    v_mul_f32 v135, v47, v135
    v_mul_f32 v144, v47, v144
    v_mul_f32 v145, v47, v145
    v_mul_f32 v146, v47, v146
    v_mul_f32 v147, v47, v147
    v_mul_f32 v156, v47, v156
    v_mul_f32 v157, v47, v157
    v_mul_f32 v158, v47, v158
    v_mul_f32 v159, v47, v159
    v_exp_f32 v36, v200
    v_exp_f32 v37, v201
    v_exp_f32 v38, v202
    v_cvt_pk_bf16_f32 v228, v36, v37
    v_add_f32 v18, v36, v37
    v_exp_f32 v39, v203
    v_exp_f32 v40, v204
    v_cvt_pk_bf16_f32 v229, v38, v39
    v_add_f32 v18, v18, v38
    v_exp_f32 v41, v205
    v_add_f32 v18, v18, v39
    v_exp_f32 v36, v206
    v_cvt_pk_bf16_f32 v230, v40, v41
    v_add_f32 v18, v18, v40
    v_exp_f32 v37, v207
    v_add_f32 v18, v18, v41
    v_add_f32 v18, v18, v36
    v_add_f32 v18, v18, v37
    v_cvt_pk_bf16_f32 v231, v36, v37
    s_nop 1
    s_branch L_ret6
L_rare8:
    s_nop 7
    v_max3_f32 v48, v160, v161, v162
    v_max3_f32 v49, v163, v164, v165
    v_max3_f32 v48, v48, v166, v167
    v_max_f32 v48, v48, v49
    v_mov_b32 v49, v48
    s_nop 1
    v_permlane16_swap_b32 v48, v49
    s_nop 1
    v_max_f32 v48, v48, v49
    v_mov_b32 v49, v48
    s_nop 1
    v_permlane32_swap_b32 v48, v49
    s_nop 1
    v_max_f32 v48, v48, v49
    v_max_f32 v42, 0, v48
    v_exp_f32 v45, -v42
    v_sub_f32 v10, v10, v42
    v_mov_b32 v52, v10
    v_mov_b32 v53, v10
    v_mov_b32 v54, v10
    v_mov_b32 v55, v10
    v_sub_f32 v160, v160, v42
    v_sub_f32 v161, v161, v42
    v_sub_f32 v162, v162, v42
    v_sub_f32 v163, v163, v42
    v_sub_f32 v164, v164, v42
    v_sub_f32 v165, v165, v42
    v_sub_f32 v166, v166, v42
    v_sub_f32 v167, v167, v42
    v_sub_f32 v184, v184, v42
    v_sub_f32 v185, v185, v42
    v_sub_f32 v186, v186, v42
    v_sub_f32 v187, v187, v42
    v_sub_f32 v188, v188, v42
    v_sub_f32 v189, v189, v42
    v_sub_f32 v190, v190, v42
    v_sub_f32 v191, v191, v42
    v_mul_f32 v13, v45, v13
    v_mul_f32 v64, v45, v64
    v_mul_f32 v65, v45, v65
    v_mul_f32 v66, v45, v66
    v_mul_f32 v67, v45, v67
    v_mul_f32 v76, v45, v76
    v_mul_f32 v77, v45, v77
    v_mul_f32 v78, v45, v78
    v_mul_f32 v79, v45, v79
    v_mul_f32 v88, v45, v88
    v_mul_f32 v89, v45, v89
    v_mul_f32 v90, v45, v90
    v_mul_f32 v91, v45, v91
    v_mul_f32 v100, v45, v100
    v_mul_f32 v101, v45, v101
    v_mul_f32 v102, v45, v102
    v_mul_f32 v103, v45, v103
    v_mul_f32 v112, v45, v112
    v_mul_f32 v113, v45, v113
    v_mul_f32 v114, v45, v114
    v_mul_f32 v115, v45, v115
    v_mul_f32 v124, v45, v124
    v_mul_f32 v125, v45, v125
    v_mul_f32 v126, v45, v126
    v_mul_f32 v127, v45, v127
    v_mul_f32 v136, v45, v136
    v_mul_f32 v137, v45, v137
    v_mul_f32 v138, v45, v138
    v_mul_f32 v139, v45, v139
    v_mul_f32 v148, v45, v148
    v_mul_f32 v149, v45, v149
    v_mul_f32 v150, v45, v150
    v_mul_f32 v151, v45, v151
    v_max3_f32 v48, v168, v169, v170
    v_max3_f32 v49, v171, v172, v173
    v_max3_f32 v48, v48, v174, v175
    v_max_f32 v48, v48, v49
    v_mov_b32 v49, v48
    s_nop 1
    v_permlane16_swap_b32 v48, v49
    s_nop 1
    v_max_f32 v48, v48, v49
    v_mov_b32 v49, v48
    s_nop 1
    v_permlane32_swap_b32 v48, v49
    s_nop 1
    v_max_f32 v48, v48, v49
    v_max_f32 v43, 0, v48
    v_exp_f32 v46, -v43
    v_sub_f32 v11, v11, v43
    v_mov_b32 v56, v11
    v_mov_b32 v57, v11
    v_mov_b32 v58, v11
    v_mov_b32 v59, v11
    v_sub_f32 v168, v168, v43
    v_sub_f32 v169, v169, v43
    v_sub_f32 v170, v170, v43
    v_sub_f32 v171, v171, v43
    v_sub_f32 v172, v172, v43
    v_sub_f32 v173, v173, v43
    v_sub_f32 v174, v174, v43
    v_sub_f32 v175, v175, v43
    v_sub_f32 v192, v192, v43
    v_sub_f32 v193, v193, v43
    v_sub_f32 v194, v194, v43
    v_sub_f32 v195, v195, v43
    v_sub_f32 v196, v196, v43
    v_sub_f32 v197, v197, v43
    v_sub_f32 v198, v198, v43
    v_sub_f32 v199, v199, v43
    v_mul_f32 v14, v46, v14
    v_mul_f32 v68, v46, v68
    v_mul_f32 v69, v46, v69
    v_mul_f32 v70, v46, v70
    v_mul_f32 v71, v46, v71
    v_mul_f32 v80, v46, v80
    v_mul_f32 v81, v46, v81
    v_mul_f32 v82, v46, v82
    v_mul_f32 v83, v46, v83
    v_mul_f32 v92, v46, v92
    v_mul_f32 v93, v46, v93
    v_mul_f32 v94, v46, v94
    v_mul_f32 v95, v46, v95
    v_mul_f32 v104, v46, v104
    v_mul_f32 v105, v46, v105
    v_mul_f32 v106, v46, v106
    v_mul_f32 v107, v46, v107
    v_mul_f32 v116, v46, v116
    v_mul_f32 v117, v46, v117
    v_mul_f32 v118, v46, v118
    v_mul_f32 v119, v46, v119
    v_mul_f32 v128, v46, v128
    v_mul_f32 v129, v46, v129
    v_mul_f32 v130, v46, v130
    v_mul_f32 v131, v46, v131
    v_mul_f32 v140, v46, v140
    v_mul_f32 v141, v46, v141
    v_mul_f32 v142, v46, v142
    v_mul_f32 v143, v46, v143
    v_mul_f32 v152, v46, v152
    v_mul_f32 v153, v46, v153
    v_mul_f32 v154, v46, v154
    v_mul_f32 v155, v46, v155
    v_max3_f32 v48, v176, v177, v178
    v_max3_f32 v49, v179, v180, v181
    v_max3_f32 v48, v48, v182, v183
    v_max_f32 v48, v48, v49
    v_mov_b32 v49, v48
    s_nop 1
    v_permlane16_swap_b32 v48, v49
    s_nop 1
    v_max_f32 v48, v48, v49
    v_mov_b32 v49, v48
    s_nop 1
    v_permlane32_swap_b32 v48, v49
    s_nop 1
    v_max_f32 v48, v48, v49
    v_max_f32 v44, 0, v48
    v_exp_f32 v47, -v44
    v_sub_f32 v12, v12, v44
    v_mov_b32 v60, v12
    v_mov_b32 v61, v12
    v_mov_b32 v62, v12
    v_mov_b32 v63, v12
    v_sub_f32 v176, v176, v44
    v_sub_f32 v177, v177, v44
    v_sub_f32 v178, v178, v44
    v_sub_f32 v179, v179, v44
    v_sub_f32 v180, v180, v44
    v_sub_f32 v181, v181, v44
    v_sub_f32 v182, v182, v44
    v_sub_f32 v183, v183, v44
    v_sub_f32 v200, v200, v44
    v_sub_f32 v201, v201, v44
    v_sub_f32 v202, v202, v44
    v_sub_f32 v203, v203, v44
    v_sub_f32 v204, v204, v44
    v_sub_f32 v205, v205, v44
    v_sub_f32 v206, v206, v44
    v_sub_f32 v207, v207, v44
    v_mul_f32 v15, v47, v15
    v_mul_f32 v72, v47, v72
    v_mul_f32 v73, v47, v73
    v_mul_f32 v74, v47, v74
    v_mul_f32 v75, v47, v75
    v_mul_f32 v84, v47, v84
    v_mul_f32 v85, v47, v85
    v_mul_f32 v86, v47, v86
    v_mul_f32 v87, v47, v87
    v_mul_f32 v96, v47, v96
    v_mul_f32 v97, v47, v97
    v_mul_f32 v98, v47, v98
    v_mul_f32 v99, v47, v99
    v_mul_f32 v108, v47, v108
    v_mul_f32 v109, v47, v109
    v_mul_f32 v110, v47, v110
    v_mul_f32 v111, v47, v111
    v_mul_f32 v120, v47, v120
    v_mul_f32 v121, v47, v121
    v_mul_f32 v122, v47, v122
    v_mul_f32 v123, v47, v123
    v_mul_f32 v132, v47, v132
    v_mul_f32 v133, v47, v133
    v_mul_f32 v134, v47, v134
    v_mul_f32 v135, v47, v135
    v_mul_f32 v144, v47, v144
    v_mul_f32 v145, v47, v145
    v_mul_f32 v146, v47, v146
    v_mul_f32 v147, v47, v147
    v_mul_f32 v156, v47, v156
    v_mul_f32 v157, v47, v157
    v_mul_f32 v158, v47, v158
    v_mul_f32 v159, v47, v159
    v_exp_f32 v36, v160
    v_exp_f32 v37, v161
    v_exp_f32 v38, v162
    v_cvt_pk_bf16_f32 v208, v36, v37
    v_add_f32 v16, v36, v37
    v_exp_f32 v39, v163
    v_exp_f32 v40, v164
    v_cvt_pk_bf16_f32 v209, v38, v39
    v_add_f32 v16, v16, v38
    v_exp_f32 v41, v165
    v_add_f32 v16, v16, v39
    v_exp_f32 v36, v166
    v_cvt_pk_bf16_f32 v210, v40, v41
    v_add_f32 v16, v16, v40
    v_exp_f32 v37, v167
    v_add_f32 v16, v16, v41
    v_exp_f32 v38, v168
    v_cvt_pk_bf16_f32 v211, v36, v37
    v_add_f32 v16, v16, v36
    v_exp_f32 v39, v169
    v_add_f32 v16, v16, v37
    v_exp_f32 v40, v170
    v_cvt_pk_bf16_f32 v212, v38, v39
    v_add_f32 v17, v38, v39
    v_exp_f32 v41, v171
    v_exp_f32 v36, v172
    v_cvt_pk_bf16_f32 v213, v40, v41
    v_add_f32 v17, v17, v40
    v_exp_f32 v37, v173
    v_add_f32 v17, v17, v41
    v_exp_f32 v38, v174
    v_cvt_pk_bf16_f32 v214, v36, v37
    v_add_f32 v17, v17, v36
    v_exp_f32 v39, v175
    v_add_f32 v17, v17, v37
    v_exp_f32 v40, v176
    v_cvt_pk_bf16_f32 v215, v38, v39
    v_add_f32 v17, v17, v38
    v_exp_f32 v41, v177
    v_add_f32 v17, v17, v39
    v_exp_f32 v36, v178
    v_cvt_pk_bf16_f32 v216, v40, v41
    v_add_f32 v18, v40, v41
    v_exp_f32 v37, v179
    v_exp_f32 v38, v180
    v_cvt_pk_bf16_f32 v217, v36, v37
    v_add_f32 v18, v18, v36
    v_exp_f32 v39, v181
    v_add_f32 v18, v18, v37
    v_exp_f32 v40, v182
    v_cvt_pk_bf16_f32 v218, v38, v39
    v_add_f32 v18, v18, v38
    v_exp_f32 v41, v183
    v_add_f32 v18, v18, v39
    v_add_f32 v18, v18, v40
    v_add_f32 v18, v18, v41
    v_cvt_pk_bf16_f32 v219, v40, v41
    s_nop 1
    s_branch L_ret8
L_rare10:
    s_nop 7
    v_max3_f32 v48, v184, v185, v186
    v_max3_f32 v49, v187, v188, v189
    v_max3_f32 v48, v48, v190, v191
    v_max_f32 v48, v48, v49
    v_mov_b32 v49, v48
    s_nop 1
    v_permlane16_swap_b32 v48, v49
    s_nop 1
    v_max_f32 v48, v48, v49
    v_mov_b32 v49, v48
    s_nop 1
    v_permlane32_swap_b32 v48, v49
    s_nop 1
    v_max_f32 v48, v48, v49
    v_max_f32 v42, 0, v48
    v_exp_f32 v45, -v42
    v_sub_f32 v10, v10, v42
    v_mov_b32 v52, v10
    v_mov_b32 v53, v10
    v_mov_b32 v54, v10
    v_mov_b32 v55, v10
    v_sub_f32 v184, v184, v42
    v_sub_f32 v185, v185, v42
    v_sub_f32 v186, v186, v42
    v_sub_f32 v187, v187, v42
    v_sub_f32 v188, v188, v42
    v_sub_f32 v189, v189, v42
    v_sub_f32 v190, v190, v42
    v_sub_f32 v191, v191, v42
    v_sub_f32 v160, v160, v42
    v_sub_f32 v161, v161, v42
    v_sub_f32 v162, v162, v42
    v_sub_f32 v163, v163, v42
    v_sub_f32 v164, v164, v42
    v_sub_f32 v165, v165, v42
    v_sub_f32 v166, v166, v42
    v_sub_f32 v167, v167, v42
    v_mul_f32 v13, v45, v13
    v_mul_f32 v64, v45, v64
    v_mul_f32 v65, v45, v65
    v_mul_f32 v66, v45, v66
    v_mul_f32 v67, v45, v67
    v_mul_f32 v76, v45, v76
    v_mul_f32 v77, v45, v77
    v_mul_f32 v78, v45, v78
    v_mul_f32 v79, v45, v79
    v_mul_f32 v88, v45, v88
    v_mul_f32 v89, v45, v89
    v_mul_f32 v90, v45, v90
    v_mul_f32 v91, v45, v91
    v_mul_f32 v100, v45, v100
    v_mul_f32 v101, v45, v101
    v_mul_f32 v102, v45, v102
    v_mul_f32 v103, v45, v103
    v_mul_f32 v112, v45, v112
    v_mul_f32 v113, v45, v113
    v_mul_f32 v114, v45, v114
    v_mul_f32 v115, v45, v115
    v_mul_f32 v124, v45, v124
    v_mul_f32 v125, v45, v125
    v_mul_f32 v126, v45, v126
    v_mul_f32 v127, v45, v127
    v_mul_f32 v136, v45, v136
    v_mul_f32 v137, v45, v137
    v_mul_f32 v138, v45, v138
    v_mul_f32 v139, v45, v139
    v_mul_f32 v148, v45, v148
    v_mul_f32 v149, v45, v149
    v_mul_f32 v150, v45, v150
    v_mul_f32 v151, v45, v151
    v_max3_f32 v48, v192, v193, v194
    v_max3_f32 v49, v195, v196, v197
    v_max3_f32 v48, v48, v198, v199
    v_max_f32 v48, v48, v49
    v_mov_b32 v49, v48
    s_nop 1
    v_permlane16_swap_b32 v48, v49
    s_nop 1
    v_max_f32 v48, v48, v49
    v_mov_b32 v49, v48
    s_nop 1
    v_permlane32_swap_b32 v48, v49
    s_nop 1
    v_max_f32 v48, v48, v49
    v_max_f32 v43, 0, v48
    v_exp_f32 v46, -v43
    v_sub_f32 v11, v11, v43
    v_mov_b32 v56, v11
    v_mov_b32 v57, v11
    v_mov_b32 v58, v11
    v_mov_b32 v59, v11
    v_sub_f32 v192, v192, v43
    v_sub_f32 v193, v193, v43
    v_sub_f32 v194, v194, v43
    v_sub_f32 v195, v195, v43
    v_sub_f32 v196, v196, v43
    v_sub_f32 v197, v197, v43
    v_sub_f32 v198, v198, v43
    v_sub_f32 v199, v199, v43
    v_sub_f32 v168, v168, v43
    v_sub_f32 v169, v169, v43
    v_sub_f32 v170, v170, v43
    v_sub_f32 v171, v171, v43
    v_sub_f32 v172, v172, v43
    v_sub_f32 v173, v173, v43
    v_sub_f32 v174, v174, v43
    v_sub_f32 v175, v175, v43
    v_mul_f32 v14, v46, v14
    v_mul_f32 v68, v46, v68
    v_mul_f32 v69, v46, v69
    v_mul_f32 v70, v46, v70
    v_mul_f32 v71, v46, v71
    v_mul_f32 v80, v46, v80
    v_mul_f32 v81, v46, v81
    v_mul_f32 v82, v46, v82
    v_mul_f32 v83, v46, v83
    v_mul_f32 v92, v46, v92
    v_mul_f32 v93, v46, v93
    v_mul_f32 v94, v46, v94
    v_mul_f32 v95, v46, v95
    v_mul_f32 v104, v46, v104
    v_mul_f32 v105, v46, v105
    v_mul_f32 v106, v46, v106
    v_mul_f32 v107, v46, v107
    v_mul_f32 v116, v46, v116
    v_mul_f32 v117, v46, v117
    v_mul_f32 v118, v46, v118
    v_mul_f32 v119, v46, v119
    v_mul_f32 v128, v46, v128
    v_mul_f32 v129, v46, v129
    v_mul_f32 v130, v46, v130
    v_mul_f32 v131, v46, v131
    v_mul_f32 v140, v46, v140
    v_mul_f32 v141, v46, v141
    v_mul_f32 v142, v46, v142
    v_mul_f32 v143, v46, v143
    v_mul_f32 v152, v46, v152
    v_mul_f32 v153, v46, v153
    v_mul_f32 v154, v46, v154
    v_mul_f32 v155, v46, v155
    v_max3_f32 v48, v200, v201, v202
    v_max3_f32 v49, v203, v204, v205
    v_max3_f32 v48, v48, v206, v207
    v_max_f32 v48, v48, v49
    v_mov_b32 v49, v48
    s_nop 1
    v_permlane16_swap_b32 v48, v49
    s_nop 1
    v_max_f32 v48, v48, v49
    v_mov_b32 v49, v48
    s_nop 1
    v_permlane32_swap_b32 v48, v49
    s_nop 1
    v_max_f32 v48, v48, v49
    v_max_f32 v44, 0, v48
    v_exp_f32 v47, -v44
    v_sub_f32 v12, v12, v44
    v_mov_b32 v60, v12
    v_mov_b32 v61, v12
    v_mov_b32 v62, v12
    v_mov_b32 v63, v12
    v_sub_f32 v200, v200, v44
    v_sub_f32 v201, v201, v44
    v_sub_f32 v202, v202, v44
    v_sub_f32 v203, v203, v44
    v_sub_f32 v204, v204, v44
    v_sub_f32 v205, v205, v44
    v_sub_f32 v206, v206, v44
    v_sub_f32 v207, v207, v44
    v_sub_f32 v176, v176, v44
    v_sub_f32 v177, v177, v44
    v_sub_f32 v178, v178, v44
    v_sub_f32 v179, v179, v44
    v_sub_f32 v180, v180, v44
    v_sub_f32 v181, v181, v44
    v_sub_f32 v182, v182, v44
    v_sub_f32 v183, v183, v44
    v_mul_f32 v15, v47, v15
    v_mul_f32 v72, v47, v72
    v_mul_f32 v73, v47, v73
    v_mul_f32 v74, v47, v74
    v_mul_f32 v75, v47, v75
    v_mul_f32 v84, v47, v84
    v_mul_f32 v85, v47, v85
    v_mul_f32 v86, v47, v86
    v_mul_f32 v87, v47, v87
    v_mul_f32 v96, v47, v96
    v_mul_f32 v97, v47, v97
    v_mul_f32 v98, v47, v98
    v_mul_f32 v99, v47, v99
    v_mul_f32 v108, v47, v108
    v_mul_f32 v109, v47, v109
    v_mul_f32 v110, v47, v110
    v_mul_f32 v111, v47, v111
    v_mul_f32 v120, v47, v120
    v_mul_f32 v121, v47, v121
    v_mul_f32 v122, v47, v122
    v_mul_f32 v123, v47, v123
    v_mul_f32 v132, v47, v132
    v_mul_f32 v133, v47, v133
    v_mul_f32 v134, v47, v134
    v_mul_f32 v135, v47, v135
    v_mul_f32 v144, v47, v144
    v_mul_f32 v145, v47, v145
    v_mul_f32 v146, v47, v146
    v_mul_f32 v147, v47, v147
    v_mul_f32 v156, v47, v156
    v_mul_f32 v157, v47, v157
    v_mul_f32 v158, v47, v158
    v_mul_f32 v159, v47, v159
    v_exp_f32 v36, v184
    v_exp_f32 v37, v185
    v_exp_f32 v38, v186
    v_cvt_pk_bf16_f32 v220, v36, v37
    v_add_f32 v16, v36, v37
    v_exp_f32 v39, v187
    v_exp_f32 v40, v188
    v_cvt_pk_bf16_f32 v221, v38, v39
    v_add_f32 v16, v16, v38
    v_exp_f32 v41, v189
    v_add_f32 v16, v16, v39
    v_exp_f32 v36, v190
    v_cvt_pk_bf16_f32 v222, v40, v41
    v_add_f32 v16, v16, v40
    v_exp_f32 v37, v191
    v_add_f32 v16, v16, v41
    v_exp_f32 v38, v192
    v_cvt_pk_bf16_f32 v223, v36, v37
    v_add_f32 v16, v16, v36
    v_exp_f32 v39, v193
    v_add_f32 v16, v16, v37
    v_exp_f32 v40, v194
    v_cvt_pk_bf16_f32 v224, v38, v39
    v_add_f32 v17, v38, v39
    v_exp_f32 v41, v195
    v_exp_f32 v36, v196
    v_cvt_pk_bf16_f32 v225, v40, v41
    v_add_f32 v17, v17, v40
    v_exp_f32 v37, v197
    v_add_f32 v17, v17, v41
    v_exp_f32 v38, v198
    v_cvt_pk_bf16_f32 v226, v36, v37
    v_add_f32 v17, v17, v36
    v_exp_f32 v39, v199
    v_add_f32 v17, v17, v37
    v_exp_f32 v40, v200
    v_cvt_pk_bf16_f32 v227, v38, v39
    v_add_f32 v17, v17, v38
    v_exp_f32 v41, v201
    v_add_f32 v17, v17, v39
    v_exp_f32 v36, v202
    v_cvt_pk_bf16_f32 v228, v40, v41
    v_add_f32 v18, v40, v41
    v_exp_f32 v37, v203
    v_exp_f32 v38, v204
    v_cvt_pk_bf16_f32 v229, v36, v37
    v_add_f32 v18, v18, v36
    v_exp_f32 v39, v205
    v_add_f32 v18, v18, v37
    v_exp_f32 v40, v206
    v_cvt_pk_bf16_f32 v230, v38, v39
    v_add_f32 v18, v18, v38
    v_exp_f32 v41, v207
    v_add_f32 v18, v18, v39
    v_add_f32 v18, v18, v40
    v_add_f32 v18, v18, v41
    v_cvt_pk_bf16_f32 v231, v40, v41
    s_nop 1
    s_branch L_ret10
L_rare12:
    s_nop 7
    v_max3_f32 v48, v160, v161, v162
    v_max3_f32 v49, v163, v164, v165
    v_max3_f32 v48, v48, v166, v167
    v_max_f32 v48, v48, v49
    v_mov_b32 v49, v48
    s_nop 1
    v_permlane16_swap_b32 v48, v49
    s_nop 1
    v_max_f32 v48, v48, v49
    v_mov_b32 v49, v48
    s_nop 1
    v_permlane32_swap_b32 v48, v49
    s_nop 1
    v_max_f32 v48, v48, v49
    v_max_f32 v42, 0, v48
    v_exp_f32 v45, -v42
    v_sub_f32 v10, v10, v42
    v_mov_b32 v52, v10
    v_mov_b32 v53, v10
    v_mov_b32 v54, v10
    v_mov_b32 v55, v10
    v_sub_f32 v160, v160, v42
    v_sub_f32 v161, v161, v42
    v_sub_f32 v162, v162, v42
    v_sub_f32 v163, v163, v42
    v_sub_f32 v164, v164, v42
    v_sub_f32 v165, v165, v42
    v_sub_f32 v166, v166, v42
    v_sub_f32 v167, v167, v42
    v_sub_f32 v184, v184, v42
    v_sub_f32 v185, v185, v42
    v_sub_f32 v186, v186, v42
    v_sub_f32 v187, v187, v42
    v_sub_f32 v188, v188, v42
    v_sub_f32 v189, v189, v42
    v_sub_f32 v190, v190, v42
    v_sub_f32 v191, v191, v42
    v_mul_f32 v13, v45, v13
    v_mul_f32 v64, v45, v64
    v_mul_f32 v65, v45, v65
    v_mul_f32 v66, v45, v66
    v_mul_f32 v67, v45, v67
    v_mul_f32 v76, v45, v76
    v_mul_f32 v77, v45, v77
    v_mul_f32 v78, v45, v78
    v_mul_f32 v79, v45, v79
    v_mul_f32 v88, v45, v88
    v_mul_f32 v89, v45, v89
    v_mul_f32 v90, v45, v90
    v_mul_f32 v91, v45, v91
    v_mul_f32 v100, v45, v100
    v_mul_f32 v101, v45, v101
    v_mul_f32 v102, v45, v102
    v_mul_f32 v103, v45, v103
    v_mul_f32 v112, v45, v112
    v_mul_f32 v113, v45, v113
    v_mul_f32 v114, v45, v114
    v_mul_f32 v115, v45, v115
    v_mul_f32 v124, v45, v124
    v_mul_f32 v125, v45, v125
    v_mul_f32 v126, v45, v126
    v_mul_f32 v127, v45, v127
    v_mul_f32 v136, v45, v136
    v_mul_f32 v137, v45, v137
    v_mul_f32 v138, v45, v138
    v_mul_f32 v139, v45, v139
    v_mul_f32 v148, v45, v148
    v_mul_f32 v149, v45, v149
    v_mul_f32 v150, v45, v150
    v_mul_f32 v151, v45, v151
    v_max3_f32 v48, v168, v169, v170
    v_max3_f32 v49, v171, v172, v173
    v_max3_f32 v48, v48, v174, v175
    v_max_f32 v48, v48, v49
    v_mov_b32 v49, v48
    s_nop 1
    v_permlane16_swap_b32 v48, v49
    s_nop 1
    v_max_f32 v48, v48, v49
    v_mov_b32 v49, v48
    s_nop 1
    v_permlane32_swap_b32 v48, v49
    s_nop 1
    v_max_f32 v48, v48, v49
    v_max_f32 v43, 0, v48
    v_exp_f32 v46, -v43
    v_sub_f32 v11, v11, v43
    v_mov_b32 v56, v11
    v_mov_b32 v57, v11
    v_mov_b32 v58, v11
    v_mov_b32 v59, v11
    v_sub_f32 v168, v168, v43
    v_sub_f32 v169, v169, v43
    v_sub_f32 v170, v170, v43
    v_sub_f32 v171, v171, v43
    v_sub_f32 v172, v172, v43
    v_sub_f32 v173, v173, v43
    v_sub_f32 v174, v174, v43
    v_sub_f32 v175, v175, v43
    v_sub_f32 v192, v192, v43
    v_sub_f32 v193, v193, v43
    v_sub_f32 v194, v194, v43
    v_sub_f32 v195, v195, v43
    v_sub_f32 v196, v196, v43
    v_sub_f32 v197, v197, v43
    v_sub_f32 v198, v198, v43
    v_sub_f32 v199, v199, v43
    v_mul_f32 v14, v46, v14
    v_mul_f32 v68, v46, v68
    v_mul_f32 v69, v46, v69
    v_mul_f32 v70, v46, v70
    v_mul_f32 v71, v46, v71
    v_mul_f32 v80, v46, v80
    v_mul_f32 v81, v46, v81
    v_mul_f32 v82, v46, v82
    v_mul_f32 v83, v46, v83
    v_mul_f32 v92, v46, v92
    v_mul_f32 v93, v46, v93
    v_mul_f32 v94, v46, v94
    v_mul_f32 v95, v46, v95
    v_mul_f32 v104, v46, v104
    v_mul_f32 v105, v46, v105
    v_mul_f32 v106, v46, v106
    v_mul_f32 v107, v46, v107
    v_mul_f32 v116, v46, v116
    v_mul_f32 v117, v46, v117
    v_mul_f32 v118, v46, v118
    v_mul_f32 v119, v46, v119
    v_mul_f32 v128, v46, v128
    v_mul_f32 v129, v46, v129
    v_mul_f32 v130, v46, v130
    v_mul_f32 v131, v46, v131
    v_mul_f32 v140, v46, v140
    v_mul_f32 v141, v46, v141
    v_mul_f32 v142, v46, v142
    v_mul_f32 v143, v46, v143
    v_mul_f32 v152, v46, v152
    v_mul_f32 v153, v46, v153
    v_mul_f32 v154, v46, v154
    v_mul_f32 v155, v46, v155
    v_max3_f32 v48, v176, v177, v178
    v_max3_f32 v49, v179, v180, v181
    v_max3_f32 v48, v48, v182, v183
    v_max_f32 v48, v48, v49
    v_mov_b32 v49, v48
    s_nop 1
    v_permlane16_swap_b32 v48, v49
    s_nop 1
    v_max_f32 v48, v48, v49
    v_mov_b32 v49, v48
    s_nop 1
    v_permlane32_swap_b32 v48, v49
    s_nop 1
    v_max_f32 v48, v48, v49
    v_max_f32 v44, 0, v48
    v_exp_f32 v47, -v44
    v_sub_f32 v12, v12, v44
    v_mov_b32 v60, v12
    v_mov_b32 v61, v12
    v_mov_b32 v62, v12
    v_mov_b32 v63, v12
    v_sub_f32 v176, v176, v44
    v_sub_f32 v177, v177, v44
    v_sub_f32 v178, v178, v44
    v_sub_f32 v179, v179, v44
    v_sub_f32 v180, v180, v44
    v_sub_f32 v181, v181, v44
    v_sub_f32 v182, v182, v44
    v_sub_f32 v183, v183, v44
    v_sub_f32 v200, v200, v44
    v_sub_f32 v201, v201, v44
    v_sub_f32 v202, v202, v44
    v_sub_f32 v203, v203, v44
    v_sub_f32 v204, v204, v44
    v_sub_f32 v205, v205, v44
    v_sub_f32 v206, v206, v44
    v_sub_f32 v207, v207, v44
    v_mul_f32 v15, v47, v15
    v_mul_f32 v72, v47, v72
    v_mul_f32 v73, v47, v73
    v_mul_f32 v74, v47, v74
    v_mul_f32 v75, v47, v75
    v_mul_f32 v84, v47, v84
    v_mul_f32 v85, v47, v85
    v_mul_f32 v86, v47, v86
    v_mul_f32 v87, v47, v87
    v_mul_f32 v96, v47, v96
    v_mul_f32 v97, v47, v97
    v_mul_f32 v98, v47, v98
    v_mul_f32 v99, v47, v99
    v_mul_f32 v108, v47, v108
    v_mul_f32 v109, v47, v109
    v_mul_f32 v110, v47, v110
    v_mul_f32 v111, v47, v111
    v_mul_f32 v120, v47, v120
    v_mul_f32 v121, v47, v121
    v_mul_f32 v122, v47, v122
    v_mul_f32 v123, v47, v123
    v_mul_f32 v132, v47, v132
    v_mul_f32 v133, v47, v133
    v_mul_f32 v134, v47, v134
    v_mul_f32 v135, v47, v135
    v_mul_f32 v144, v47, v144
    v_mul_f32 v145, v47, v145
    v_mul_f32 v146, v47, v146
    v_mul_f32 v147, v47, v147
    v_mul_f32 v156, v47, v156
    v_mul_f32 v157, v47, v157
    v_mul_f32 v158, v47, v158
    v_mul_f32 v159, v47, v159
    v_exp_f32 v36, v160
    v_exp_f32 v37, v161
    v_exp_f32 v38, v162
    v_cvt_pk_bf16_f32 v208, v36, v37
    v_add_f32 v16, v36, v37
    v_exp_f32 v39, v163
    v_exp_f32 v40, v164
    v_cvt_pk_bf16_f32 v209, v38, v39
    v_add_f32 v16, v16, v38
    v_exp_f32 v41, v165
    v_add_f32 v16, v16, v39
    v_exp_f32 v36, v166
    v_cvt_pk_bf16_f32 v210, v40, v41
    v_add_f32 v16, v16, v40
    v_exp_f32 v37, v167
    v_add_f32 v16, v16, v41
    v_exp_f32 v38, v168
    v_cvt_pk_bf16_f32 v211, v36, v37
    v_add_f32 v16, v16, v36
    v_exp_f32 v39, v169
    v_add_f32 v16, v16, v37
    v_exp_f32 v40, v170
    v_cvt_pk_bf16_f32 v212, v38, v39
    v_add_f32 v17, v38, v39
    v_exp_f32 v41, v171
    v_exp_f32 v36, v172
    v_cvt_pk_bf16_f32 v213, v40, v41
    v_add_f32 v17, v17, v40
    v_exp_f32 v37, v173
    v_add_f32 v17, v17, v41
    v_exp_f32 v38, v174
    v_cvt_pk_bf16_f32 v214, v36, v37
    v_add_f32 v17, v17, v36
    v_exp_f32 v39, v175
    v_add_f32 v17, v17, v37
    v_exp_f32 v40, v176
    v_cvt_pk_bf16_f32 v215, v38, v39
    v_add_f32 v17, v17, v38
    v_exp_f32 v41, v177
    v_add_f32 v17, v17, v39
    v_exp_f32 v36, v178
    v_cvt_pk_bf16_f32 v216, v40, v41
    v_add_f32 v18, v40, v41
    v_exp_f32 v37, v179
    v_exp_f32 v38, v180
    v_cvt_pk_bf16_f32 v217, v36, v37
    v_add_f32 v18, v18, v36
    v_exp_f32 v39, v181
    v_add_f32 v18, v18, v37
    v_exp_f32 v40, v182
    v_cvt_pk_bf16_f32 v218, v38, v39
    v_add_f32 v18, v18, v38
    v_exp_f32 v41, v183
    v_add_f32 v18, v18, v39
    v_add_f32 v18, v18, v40
    v_add_f32 v18, v18, v41
    v_cvt_pk_bf16_f32 v219, v40, v41
    s_nop 1
    s_branch L_ret12
L_rare13:
    s_nop 7
    v_max3_f32 v48, v184, v185, v186
    v_max3_f32 v49, v187, v188, v189
    v_max3_f32 v48, v48, v190, v191
    v_max_f32 v48, v48, v49
    v_mov_b32 v49, v48
    s_nop 1
    v_permlane16_swap_b32 v48, v49
    s_nop 1
    v_max_f32 v48, v48, v49
    v_mov_b32 v49, v48
    s_nop 1
    v_permlane32_swap_b32 v48, v49
    s_nop 1
    v_max_f32 v48, v48, v49
    v_max_f32 v42, 0, v48
    v_exp_f32 v45, -v42
    v_sub_f32 v10, v10, v42
    v_mov_b32 v52, v10
    v_mov_b32 v53, v10
    v_mov_b32 v54, v10
    v_mov_b32 v55, v10
    v_sub_f32 v184, v184, v42
    v_sub_f32 v185, v185, v42
    v_sub_f32 v186, v186, v42
    v_sub_f32 v187, v187, v42
    v_sub_f32 v188, v188, v42
    v_sub_f32 v189, v189, v42
    v_sub_f32 v190, v190, v42
    v_sub_f32 v191, v191, v42
    v_sub_f32 v160, v160, v42
    v_sub_f32 v161, v161, v42
    v_sub_f32 v162, v162, v42
    v_sub_f32 v163, v163, v42
    v_sub_f32 v164, v164, v42
    v_sub_f32 v165, v165, v42
    v_sub_f32 v166, v166, v42
    v_sub_f32 v167, v167, v42
    v_mul_f32 v13, v45, v13
    v_mul_f32 v64, v45, v64
    v_mul_f32 v65, v45, v65
    v_mul_f32 v66, v45, v66
    v_mul_f32 v67, v45, v67
    v_mul_f32 v76, v45, v76
    v_mul_f32 v77, v45, v77
    v_mul_f32 v78, v45, v78
    v_mul_f32 v79, v45, v79
    v_mul_f32 v88, v45, v88
    v_mul_f32 v89, v45, v89
    v_mul_f32 v90, v45, v90
    v_mul_f32 v91, v45, v91
    v_mul_f32 v100, v45, v100
    v_mul_f32 v101, v45, v101
    v_mul_f32 v102, v45, v102
    v_mul_f32 v103, v45, v103
    v_mul_f32 v112, v45, v112
    v_mul_f32 v113, v45, v113
    v_mul_f32 v114, v45, v114
    v_mul_f32 v115, v45, v115
    v_mul_f32 v124, v45, v124
    v_mul_f32 v125, v45, v125
    v_mul_f32 v126, v45, v126
    v_mul_f32 v127, v45, v127
    v_mul_f32 v136, v45, v136
    v_mul_f32 v137, v45, v137
    v_mul_f32 v138, v45, v138
    v_mul_f32 v139, v45, v139
    v_mul_f32 v148, v45, v148
    v_mul_f32 v149, v45, v149
    v_mul_f32 v150, v45, v150
    v_mul_f32 v151, v45, v151
    v_max3_f32 v48, v192, v193, v194
    v_max3_f32 v49, v195, v196, v197
    v_max3_f32 v48, v48, v198, v199
    v_max_f32 v48, v48, v49
    v_mov_b32 v49, v48
    s_nop 1
    v_permlane16_swap_b32 v48, v49
    s_nop 1
    v_max_f32 v48, v48, v49
    v_mov_b32 v49, v48
    s_nop 1
    v_permlane32_swap_b32 v48, v49
    s_nop 1
    v_max_f32 v48, v48, v49
    v_max_f32 v43, 0, v48
    v_exp_f32 v46, -v43
    v_sub_f32 v11, v11, v43
    v_mov_b32 v56, v11
    v_mov_b32 v57, v11
    v_mov_b32 v58, v11
    v_mov_b32 v59, v11
    v_sub_f32 v192, v192, v43
    v_sub_f32 v193, v193, v43
    v_sub_f32 v194, v194, v43
    v_sub_f32 v195, v195, v43
    v_sub_f32 v196, v196, v43
    v_sub_f32 v197, v197, v43
    v_sub_f32 v198, v198, v43
    v_sub_f32 v199, v199, v43
    v_sub_f32 v168, v168, v43
    v_sub_f32 v169, v169, v43
    v_sub_f32 v170, v170, v43
    v_sub_f32 v171, v171, v43
    v_sub_f32 v172, v172, v43
    v_sub_f32 v173, v173, v43
    v_sub_f32 v174, v174, v43
    v_sub_f32 v175, v175, v43
    v_mul_f32 v14, v46, v14
    v_mul_f32 v68, v46, v68
    v_mul_f32 v69, v46, v69
    v_mul_f32 v70, v46, v70
    v_mul_f32 v71, v46, v71
    v_mul_f32 v80, v46, v80
    v_mul_f32 v81, v46, v81
    v_mul_f32 v82, v46, v82
    v_mul_f32 v83, v46, v83
    v_mul_f32 v92, v46, v92
    v_mul_f32 v93, v46, v93
    v_mul_f32 v94, v46, v94
    v_mul_f32 v95, v46, v95
    v_mul_f32 v104, v46, v104
    v_mul_f32 v105, v46, v105
    v_mul_f32 v106, v46, v106
    v_mul_f32 v107, v46, v107
    v_mul_f32 v116, v46, v116
    v_mul_f32 v117, v46, v117
    v_mul_f32 v118, v46, v118
    v_mul_f32 v119, v46, v119
    v_mul_f32 v128, v46, v128
    v_mul_f32 v129, v46, v129
    v_mul_f32 v130, v46, v130
    v_mul_f32 v131, v46, v131
    v_mul_f32 v140, v46, v140
    v_mul_f32 v141, v46, v141
    v_mul_f32 v142, v46, v142
    v_mul_f32 v143, v46, v143
    v_mul_f32 v152, v46, v152
    v_mul_f32 v153, v46, v153
    v_mul_f32 v154, v46, v154
    v_mul_f32 v155, v46, v155
    v_max3_f32 v48, v200, v201, v202
    v_max3_f32 v49, v203, v204, v205
    v_max3_f32 v48, v48, v206, v207
    v_max_f32 v48, v48, v49
    v_mov_b32 v49, v48
    s_nop 1
    v_permlane16_swap_b32 v48, v49
    s_nop 1
    v_max_f32 v48, v48, v49
    v_mov_b32 v49, v48
    s_nop 1
    v_permlane32_swap_b32 v48, v49
    s_nop 1
    v_max_f32 v48, v48, v49
    v_max_f32 v44, 0, v48
    v_exp_f32 v47, -v44
    v_sub_f32 v12, v12, v44
    v_mov_b32 v60, v12
    v_mov_b32 v61, v12
    v_mov_b32 v62, v12
    v_mov_b32 v63, v12
    v_sub_f32 v200, v200, v44
    v_sub_f32 v201, v201, v44
    v_sub_f32 v202, v202, v44
    v_sub_f32 v203, v203, v44
    v_sub_f32 v204, v204, v44
    v_sub_f32 v205, v205, v44
    v_sub_f32 v206, v206, v44
    v_sub_f32 v207, v207, v44
    v_sub_f32 v176, v176, v44
    v_sub_f32 v177, v177, v44
    v_sub_f32 v178, v178, v44
    v_sub_f32 v179, v179, v44
    v_sub_f32 v180, v180, v44
    v_sub_f32 v181, v181, v44
    v_sub_f32 v182, v182, v44
    v_sub_f32 v183, v183, v44
    v_mul_f32 v15, v47, v15
    v_mul_f32 v72, v47, v72
    v_mul_f32 v73, v47, v73
    v_mul_f32 v74, v47, v74
    v_mul_f32 v75, v47, v75
    v_mul_f32 v84, v47, v84
    v_mul_f32 v85, v47, v85
    v_mul_f32 v86, v47, v86
    v_mul_f32 v87, v47, v87
    v_mul_f32 v96, v47, v96
    v_mul_f32 v97, v47, v97
    v_mul_f32 v98, v47, v98
    v_mul_f32 v99, v47, v99
    v_mul_f32 v108, v47, v108
    v_mul_f32 v109, v47, v109
    v_mul_f32 v110, v47, v110
    v_mul_f32 v111, v47, v111
    v_mul_f32 v120, v47, v120
    v_mul_f32 v121, v47, v121
    v_mul_f32 v122, v47, v122
    v_mul_f32 v123, v47, v123
    v_mul_f32 v132, v47, v132
    v_mul_f32 v133, v47, v133
    v_mul_f32 v134, v47, v134
    v_mul_f32 v135, v47, v135
    v_mul_f32 v144, v47, v144
    v_mul_f32 v145, v47, v145
    v_mul_f32 v146, v47, v146
    v_mul_f32 v147, v47, v147
    v_mul_f32 v156, v47, v156
    v_mul_f32 v157, v47, v157
    v_mul_f32 v158, v47, v158
    v_mul_f32 v159, v47, v159
    v_exp_f32 v36, v184
    v_exp_f32 v37, v185
    v_exp_f32 v38, v186
    v_cvt_pk_bf16_f32 v220, v36, v37
    v_add_f32 v16, v36, v37
    v_exp_f32 v39, v187
    v_exp_f32 v40, v188
    v_cvt_pk_bf16_f32 v221, v38, v39
    v_add_f32 v16, v16, v38
    v_exp_f32 v41, v189
    v_add_f32 v16, v16, v39
    v_exp_f32 v36, v190
    v_cvt_pk_bf16_f32 v222, v40, v41
    v_add_f32 v16, v16, v40
    v_exp_f32 v37, v191
    v_add_f32 v16, v16, v41
    v_exp_f32 v38, v192
    v_cvt_pk_bf16_f32 v223, v36, v37
    v_add_f32 v16, v16, v36
    v_exp_f32 v39, v193
    v_add_f32 v16, v16, v37
    v_exp_f32 v40, v194
    v_cvt_pk_bf16_f32 v224, v38, v39
    v_add_f32 v17, v38, v39
    v_exp_f32 v41, v195
    v_exp_f32 v36, v196
    v_cvt_pk_bf16_f32 v225, v40, v41
    v_add_f32 v17, v17, v40
    v_exp_f32 v37, v197
    v_add_f32 v17, v17, v41
    v_exp_f32 v38, v198
    v_cvt_pk_bf16_f32 v226, v36, v37
    v_add_f32 v17, v17, v36
    v_exp_f32 v39, v199
    v_add_f32 v17, v17, v37
    v_exp_f32 v40, v200
    v_cvt_pk_bf16_f32 v227, v38, v39
    v_add_f32 v17, v17, v38
    v_exp_f32 v41, v201
    v_add_f32 v17, v17, v39
    v_exp_f32 v36, v202
    v_cvt_pk_bf16_f32 v228, v40, v41
    v_add_f32 v18, v40, v41
    v_exp_f32 v37, v203
    v_exp_f32 v38, v204
    v_cvt_pk_bf16_f32 v229, v36, v37
    v_add_f32 v18, v18, v36
    v_exp_f32 v39, v205
    v_add_f32 v18, v18, v37
    v_exp_f32 v40, v206
    v_cvt_pk_bf16_f32 v230, v38, v39
    v_add_f32 v18, v18, v38
    v_exp_f32 v41, v207
    v_add_f32 v18, v18, v39
    v_add_f32 v18, v18, v40
    v_add_f32 v18, v18, v41
    v_cvt_pk_bf16_f32 v231, v40, v41
    s_nop 1
    s_branch L_ret13
L_rare14:
    s_nop 7
    v_max3_f32 v48, v160, v161, v162
    v_max3_f32 v49, v163, v164, v165
    v_max3_f32 v48, v48, v166, v167
    v_max_f32 v48, v48, v49
    v_mov_b32 v49, v48
    s_nop 1
    v_permlane16_swap_b32 v48, v49
    s_nop 1
    v_max_f32 v48, v48, v49
    v_mov_b32 v49, v48
    s_nop 1
    v_permlane32_swap_b32 v48, v49
    s_nop 1
    v_max_f32 v48, v48, v49
    v_max_f32 v42, 0, v48
    v_exp_f32 v45, -v42
    v_sub_f32 v10, v10, v42
    v_mov_b32 v52, v10
    v_mov_b32 v53, v10
    v_mov_b32 v54, v10
    v_mov_b32 v55, v10
    v_sub_f32 v160, v160, v42
    v_sub_f32 v161, v161, v42
    v_sub_f32 v162, v162, v42
    v_sub_f32 v163, v163, v42
    v_sub_f32 v164, v164, v42
    v_sub_f32 v165, v165, v42
    v_sub_f32 v166, v166, v42
    v_sub_f32 v167, v167, v42
    v_sub_f32 v184, v184, v42
    v_sub_f32 v185, v185, v42
    v_sub_f32 v186, v186, v42
    v_sub_f32 v187, v187, v42
    v_sub_f32 v188, v188, v42
    v_sub_f32 v189, v189, v42
    v_sub_f32 v190, v190, v42
    v_sub_f32 v191, v191, v42
    v_mul_f32 v13, v45, v13
    v_mul_f32 v64, v45, v64
    v_mul_f32 v65, v45, v65
    v_mul_f32 v66, v45, v66
    v_mul_f32 v67, v45, v67
    v_mul_f32 v76, v45, v76
    v_mul_f32 v77, v45, v77
    v_mul_f32 v78, v45, v78
    v_mul_f32 v79, v45, v79
    v_mul_f32 v88, v45, v88
    v_mul_f32 v89, v45, v89
    v_mul_f32 v90, v45, v90
    v_mul_f32 v91, v45, v91
    v_mul_f32 v100, v45, v100
    v_mul_f32 v101, v45, v101
    v_mul_f32 v102, v45, v102
    v_mul_f32 v103, v45, v103
    v_mul_f32 v112, v45, v112
    v_mul_f32 v113, v45, v113
    v_mul_f32 v114, v45, v114
    v_mul_f32 v115, v45, v115
    v_mul_f32 v124, v45, v124
    v_mul_f32 v125, v45, v125
    v_mul_f32 v126, v45, v126
    v_mul_f32 v127, v45, v127
    v_mul_f32 v136, v45, v136
    v_mul_f32 v137, v45, v137
    v_mul_f32 v138, v45, v138
    v_mul_f32 v139, v45, v139
    v_mul_f32 v148, v45, v148
    v_mul_f32 v149, v45, v149
    v_mul_f32 v150, v45, v150
    v_mul_f32 v151, v45, v151
    v_max3_f32 v48, v168, v169, v170
    v_max3_f32 v49, v171, v172, v173
    v_max3_f32 v48, v48, v174, v175
    v_max_f32 v48, v48, v49
    v_mov_b32 v49, v48
    s_nop 1
    v_permlane16_swap_b32 v48, v49
    s_nop 1
    v_max_f32 v48, v48, v49
    v_mov_b32 v49, v48
    s_nop 1
    v_permlane32_swap_b32 v48, v49
    s_nop 1
    v_max_f32 v48, v48, v49
    v_max_f32 v43, 0, v48
    v_exp_f32 v46, -v43
    v_sub_f32 v11, v11, v43
    v_mov_b32 v56, v11
    v_mov_b32 v57, v11
    v_mov_b32 v58, v11
    v_mov_b32 v59, v11
    v_sub_f32 v168, v168, v43
    v_sub_f32 v169, v169, v43
    v_sub_f32 v170, v170, v43
    v_sub_f32 v171, v171, v43
    v_sub_f32 v172, v172, v43
    v_sub_f32 v173, v173, v43
    v_sub_f32 v174, v174, v43
    v_sub_f32 v175, v175, v43
    v_sub_f32 v192, v192, v43
    v_sub_f32 v193, v193, v43
    v_sub_f32 v194, v194, v43
    v_sub_f32 v195, v195, v43
    v_sub_f32 v196, v196, v43
    v_sub_f32 v197, v197, v43
    v_sub_f32 v198, v198, v43
    v_sub_f32 v199, v199, v43
    v_mul_f32 v14, v46, v14
    v_mul_f32 v68, v46, v68
    v_mul_f32 v69, v46, v69
    v_mul_f32 v70, v46, v70
    v_mul_f32 v71, v46, v71
    v_mul_f32 v80, v46, v80
    v_mul_f32 v81, v46, v81
    v_mul_f32 v82, v46, v82
    v_mul_f32 v83, v46, v83
    v_mul_f32 v92, v46, v92
    v_mul_f32 v93, v46, v93
    v_mul_f32 v94, v46, v94
    v_mul_f32 v95, v46, v95
    v_mul_f32 v104, v46, v104
    v_mul_f32 v105, v46, v105
    v_mul_f32 v106, v46, v106
    v_mul_f32 v107, v46, v107
    v_mul_f32 v116, v46, v116
    v_mul_f32 v117, v46, v117
    v_mul_f32 v118, v46, v118
    v_mul_f32 v119, v46, v119
    v_mul_f32 v128, v46, v128
    v_mul_f32 v129, v46, v129
    v_mul_f32 v130, v46, v130
    v_mul_f32 v131, v46, v131
    v_mul_f32 v140, v46, v140
    v_mul_f32 v141, v46, v141
    v_mul_f32 v142, v46, v142
    v_mul_f32 v143, v46, v143
    v_mul_f32 v152, v46, v152
    v_mul_f32 v153, v46, v153
    v_mul_f32 v154, v46, v154
    v_mul_f32 v155, v46, v155
    v_max3_f32 v48, v176, v177, v178
    v_max3_f32 v49, v179, v180, v181
    v_max3_f32 v48, v48, v182, v183
    v_max_f32 v48, v48, v49
    v_mov_b32 v49, v48
    s_nop 1
    v_permlane16_swap_b32 v48, v49
    s_nop 1
    v_max_f32 v48, v48, v49
    v_mov_b32 v49, v48
    s_nop 1
    v_permlane32_swap_b32 v48, v49
    s_nop 1
    v_max_f32 v48, v48, v49
    v_max_f32 v44, 0, v48
    v_exp_f32 v47, -v44
    v_sub_f32 v12, v12, v44
    v_mov_b32 v60, v12
    v_mov_b32 v61, v12
    v_mov_b32 v62, v12
    v_mov_b32 v63, v12
    v_sub_f32 v176, v176, v44
    v_sub_f32 v177, v177, v44
    v_sub_f32 v178, v178, v44
    v_sub_f32 v179, v179, v44
    v_sub_f32 v180, v180, v44
    v_sub_f32 v181, v181, v44
    v_sub_f32 v182, v182, v44
    v_sub_f32 v183, v183, v44
    v_sub_f32 v200, v200, v44
    v_sub_f32 v201, v201, v44
    v_sub_f32 v202, v202, v44
    v_sub_f32 v203, v203, v44
    v_sub_f32 v204, v204, v44
    v_sub_f32 v205, v205, v44
    v_sub_f32 v206, v206, v44
    v_sub_f32 v207, v207, v44
    v_mul_f32 v15, v47, v15
    v_mul_f32 v72, v47, v72
    v_mul_f32 v73, v47, v73
    v_mul_f32 v74, v47, v74
    v_mul_f32 v75, v47, v75
    v_mul_f32 v84, v47, v84
    v_mul_f32 v85, v47, v85
    v_mul_f32 v86, v47, v86
    v_mul_f32 v87, v47, v87
    v_mul_f32 v96, v47, v96
    v_mul_f32 v97, v47, v97
    v_mul_f32 v98, v47, v98
    v_mul_f32 v99, v47, v99
    v_mul_f32 v108, v47, v108
    v_mul_f32 v109, v47, v109
    v_mul_f32 v110, v47, v110
    v_mul_f32 v111, v47, v111
    v_mul_f32 v120, v47, v120
    v_mul_f32 v121, v47, v121
    v_mul_f32 v122, v47, v122
    v_mul_f32 v123, v47, v123
    v_mul_f32 v132, v47, v132
    v_mul_f32 v133, v47, v133
    v_mul_f32 v134, v47, v134
    v_mul_f32 v135, v47, v135
    v_mul_f32 v144, v47, v144
    v_mul_f32 v145, v47, v145
    v_mul_f32 v146, v47, v146
    v_mul_f32 v147, v47, v147
    v_mul_f32 v156, v47, v156
    v_mul_f32 v157, v47, v157
    v_mul_f32 v158, v47, v158
    v_mul_f32 v159, v47, v159
    v_exp_f32 v36, v160
    v_exp_f32 v37, v161
    v_exp_f32 v38, v162
    v_cvt_pk_bf16_f32 v208, v36, v37
    v_add_f32 v16, v36, v37
    v_exp_f32 v39, v163
    v_exp_f32 v40, v164
    v_cvt_pk_bf16_f32 v209, v38, v39
    v_add_f32 v16, v16, v38
    v_exp_f32 v41, v165
    v_add_f32 v16, v16, v39
    v_exp_f32 v36, v166
    v_cvt_pk_bf16_f32 v210, v40, v41
    v_add_f32 v16, v16, v40
    v_exp_f32 v37, v167
    v_add_f32 v16, v16, v41
    v_exp_f32 v38, v168
    v_cvt_pk_bf16_f32 v211, v36, v37
    v_add_f32 v16, v16, v36
    v_exp_f32 v39, v169
    v_add_f32 v16, v16, v37
    v_exp_f32 v40, v170
    v_cvt_pk_bf16_f32 v212, v38, v39
    v_add_f32 v17, v38, v39
    v_exp_f32 v41, v171
    v_exp_f32 v36, v172
    v_cvt_pk_bf16_f32 v213, v40, v41
    v_add_f32 v17, v17, v40
    v_exp_f32 v37, v173
    v_add_f32 v17, v17, v41
    v_exp_f32 v38, v174
    v_cvt_pk_bf16_f32 v214, v36, v37
    v_add_f32 v17, v17, v36
    v_exp_f32 v39, v175
    v_add_f32 v17, v17, v37
    v_exp_f32 v40, v176
    v_cvt_pk_bf16_f32 v215, v38, v39
    v_add_f32 v17, v17, v38
    v_exp_f32 v41, v177
    v_add_f32 v17, v17, v39
    v_exp_f32 v36, v178
    v_cvt_pk_bf16_f32 v216, v40, v41
    v_add_f32 v18, v40, v41
    v_exp_f32 v37, v179
    v_exp_f32 v38, v180
    v_cvt_pk_bf16_f32 v217, v36, v37
    v_add_f32 v18, v18, v36
    v_exp_f32 v39, v181
    v_add_f32 v18, v18, v37
    v_exp_f32 v40, v182
    v_cvt_pk_bf16_f32 v218, v38, v39
    v_add_f32 v18, v18, v38
    v_exp_f32 v41, v183
    v_add_f32 v18, v18, v39
    v_add_f32 v18, v18, v40
    v_add_f32 v18, v18, v41
    v_cvt_pk_bf16_f32 v219, v40, v41
    s_nop 1
    s_branch L_ret14
L_rare15:
    s_nop 7
    v_max3_f32 v48, v184, v185, v186
    v_max3_f32 v49, v187, v188, v189
    v_max3_f32 v48, v48, v190, v191
    v_max_f32 v48, v48, v49
    v_mov_b32 v49, v48
    s_nop 1
    v_permlane16_swap_b32 v48, v49
    s_nop 1
    v_max_f32 v48, v48, v49
    v_mov_b32 v49, v48
    s_nop 1
    v_permlane32_swap_b32 v48, v49
    s_nop 1
    v_max_f32 v48, v48, v49
    v_max_f32 v42, 0, v48
    v_exp_f32 v45, -v42
    v_sub_f32 v10, v10, v42
    v_mov_b32 v52, v10
    v_mov_b32 v53, v10
    v_mov_b32 v54, v10
    v_mov_b32 v55, v10
    v_sub_f32 v184, v184, v42
    v_sub_f32 v185, v185, v42
    v_sub_f32 v186, v186, v42
    v_sub_f32 v187, v187, v42
    v_sub_f32 v188, v188, v42
    v_sub_f32 v189, v189, v42
    v_sub_f32 v190, v190, v42
    v_sub_f32 v191, v191, v42
    v_sub_f32 v160, v160, v42
    v_sub_f32 v161, v161, v42
    v_sub_f32 v162, v162, v42
    v_sub_f32 v163, v163, v42
    v_sub_f32 v164, v164, v42
    v_sub_f32 v165, v165, v42
    v_sub_f32 v166, v166, v42
    v_sub_f32 v167, v167, v42
    v_mul_f32 v13, v45, v13
    v_mul_f32 v64, v45, v64
    v_mul_f32 v65, v45, v65
    v_mul_f32 v66, v45, v66
    v_mul_f32 v67, v45, v67
    v_mul_f32 v76, v45, v76
    v_mul_f32 v77, v45, v77
    v_mul_f32 v78, v45, v78
    v_mul_f32 v79, v45, v79
    v_mul_f32 v88, v45, v88
    v_mul_f32 v89, v45, v89
    v_mul_f32 v90, v45, v90
    v_mul_f32 v91, v45, v91
    v_mul_f32 v100, v45, v100
    v_mul_f32 v101, v45, v101
    v_mul_f32 v102, v45, v102
    v_mul_f32 v103, v45, v103
    v_mul_f32 v112, v45, v112
    v_mul_f32 v113, v45, v113
    v_mul_f32 v114, v45, v114
    v_mul_f32 v115, v45, v115
    v_mul_f32 v124, v45, v124
    v_mul_f32 v125, v45, v125
    v_mul_f32 v126, v45, v126
    v_mul_f32 v127, v45, v127
    v_mul_f32 v136, v45, v136
    v_mul_f32 v137, v45, v137
    v_mul_f32 v138, v45, v138
    v_mul_f32 v139, v45, v139
    v_mul_f32 v148, v45, v148
    v_mul_f32 v149, v45, v149
    v_mul_f32 v150, v45, v150
    v_mul_f32 v151, v45, v151
    v_max3_f32 v48, v192, v193, v194
    v_max3_f32 v49, v195, v196, v197
    v_max3_f32 v48, v48, v198, v199
    v_max_f32 v48, v48, v49
    v_mov_b32 v49, v48
    s_nop 1
    v_permlane16_swap_b32 v48, v49
    s_nop 1
    v_max_f32 v48, v48, v49
    v_mov_b32 v49, v48
    s_nop 1
    v_permlane32_swap_b32 v48, v49
    s_nop 1
    v_max_f32 v48, v48, v49
    v_max_f32 v43, 0, v48
    v_exp_f32 v46, -v43
    v_sub_f32 v11, v11, v43
    v_mov_b32 v56, v11
    v_mov_b32 v57, v11
    v_mov_b32 v58, v11
    v_mov_b32 v59, v11
    v_sub_f32 v192, v192, v43
    v_sub_f32 v193, v193, v43
    v_sub_f32 v194, v194, v43
    v_sub_f32 v195, v195, v43
    v_sub_f32 v196, v196, v43
    v_sub_f32 v197, v197, v43
    v_sub_f32 v198, v198, v43
    v_sub_f32 v199, v199, v43
    v_sub_f32 v168, v168, v43
    v_sub_f32 v169, v169, v43
    v_sub_f32 v170, v170, v43
    v_sub_f32 v171, v171, v43
    v_sub_f32 v172, v172, v43
    v_sub_f32 v173, v173, v43
    v_sub_f32 v174, v174, v43
    v_sub_f32 v175, v175, v43
    v_mul_f32 v14, v46, v14
    v_mul_f32 v68, v46, v68
    v_mul_f32 v69, v46, v69
    v_mul_f32 v70, v46, v70
    v_mul_f32 v71, v46, v71
    v_mul_f32 v80, v46, v80
    v_mul_f32 v81, v46, v81
    v_mul_f32 v82, v46, v82
    v_mul_f32 v83, v46, v83
    v_mul_f32 v92, v46, v92
    v_mul_f32 v93, v46, v93
    v_mul_f32 v94, v46, v94
    v_mul_f32 v95, v46, v95
    v_mul_f32 v104, v46, v104
    v_mul_f32 v105, v46, v105
    v_mul_f32 v106, v46, v106
    v_mul_f32 v107, v46, v107
    v_mul_f32 v116, v46, v116
    v_mul_f32 v117, v46, v117
    v_mul_f32 v118, v46, v118
    v_mul_f32 v119, v46, v119
    v_mul_f32 v128, v46, v128
    v_mul_f32 v129, v46, v129
    v_mul_f32 v130, v46, v130
    v_mul_f32 v131, v46, v131
    v_mul_f32 v140, v46, v140
    v_mul_f32 v141, v46, v141
    v_mul_f32 v142, v46, v142
    v_mul_f32 v143, v46, v143
    v_mul_f32 v152, v46, v152
    v_mul_f32 v153, v46, v153
    v_mul_f32 v154, v46, v154
    v_mul_f32 v155, v46, v155
    v_max3_f32 v48, v200, v201, v202
    v_max3_f32 v49, v203, v204, v205
    v_max3_f32 v48, v48, v206, v207
    v_max_f32 v48, v48, v49
    v_mov_b32 v49, v48
    s_nop 1
    v_permlane16_swap_b32 v48, v49
    s_nop 1
    v_max_f32 v48, v48, v49
    v_mov_b32 v49, v48
    s_nop 1
    v_permlane32_swap_b32 v48, v49
    s_nop 1
    v_max_f32 v48, v48, v49
    v_max_f32 v44, 0, v48
    v_exp_f32 v47, -v44
    v_sub_f32 v12, v12, v44
    v_mov_b32 v60, v12
    v_mov_b32 v61, v12
    v_mov_b32 v62, v12
    v_mov_b32 v63, v12
    v_sub_f32 v200, v200, v44
    v_sub_f32 v201, v201, v44
    v_sub_f32 v202, v202, v44
    v_sub_f32 v203, v203, v44
    v_sub_f32 v204, v204, v44
    v_sub_f32 v205, v205, v44
    v_sub_f32 v206, v206, v44
    v_sub_f32 v207, v207, v44
    v_sub_f32 v176, v176, v44
    v_sub_f32 v177, v177, v44
    v_sub_f32 v178, v178, v44
    v_sub_f32 v179, v179, v44
    v_sub_f32 v180, v180, v44
    v_sub_f32 v181, v181, v44
    v_sub_f32 v182, v182, v44
    v_sub_f32 v183, v183, v44
    v_mul_f32 v15, v47, v15
    v_mul_f32 v72, v47, v72
    v_mul_f32 v73, v47, v73
    v_mul_f32 v74, v47, v74
    v_mul_f32 v75, v47, v75
    v_mul_f32 v84, v47, v84
    v_mul_f32 v85, v47, v85
    v_mul_f32 v86, v47, v86
    v_mul_f32 v87, v47, v87
    v_mul_f32 v96, v47, v96
    v_mul_f32 v97, v47, v97
    v_mul_f32 v98, v47, v98
    v_mul_f32 v99, v47, v99
    v_mul_f32 v108, v47, v108
    v_mul_f32 v109, v47, v109
    v_mul_f32 v110, v47, v110
    v_mul_f32 v111, v47, v111
    v_mul_f32 v120, v47, v120
    v_mul_f32 v121, v47, v121
    v_mul_f32 v122, v47, v122
    v_mul_f32 v123, v47, v123
    v_mul_f32 v132, v47, v132
    v_mul_f32 v133, v47, v133
    v_mul_f32 v134, v47, v134
    v_mul_f32 v135, v47, v135
    v_mul_f32 v144, v47, v144
    v_mul_f32 v145, v47, v145
    v_mul_f32 v146, v47, v146
    v_mul_f32 v147, v47, v147
    v_mul_f32 v156, v47, v156
    v_mul_f32 v157, v47, v157
    v_mul_f32 v158, v47, v158
    v_mul_f32 v159, v47, v159
    v_exp_f32 v36, v184
    v_exp_f32 v37, v185
    v_exp_f32 v38, v186
    v_cvt_pk_bf16_f32 v220, v36, v37
    v_add_f32 v16, v36, v37
    v_exp_f32 v39, v187
    v_exp_f32 v40, v188
    v_cvt_pk_bf16_f32 v221, v38, v39
    v_add_f32 v16, v16, v38
    v_exp_f32 v41, v189
    v_add_f32 v16, v16, v39
    v_exp_f32 v36, v190
    v_cvt_pk_bf16_f32 v222, v40, v41
    v_add_f32 v16, v16, v40
    v_exp_f32 v37, v191
    v_add_f32 v16, v16, v41
    v_exp_f32 v38, v192
    v_cvt_pk_bf16_f32 v223, v36, v37
    v_add_f32 v16, v16, v36
    v_exp_f32 v39, v193
    v_add_f32 v16, v16, v37
    v_exp_f32 v40, v194
    v_cvt_pk_bf16_f32 v224, v38, v39
    v_add_f32 v17, v38, v39
    v_exp_f32 v41, v195
    v_exp_f32 v36, v196
    v_cvt_pk_bf16_f32 v225, v40, v41
    v_add_f32 v17, v17, v40
    v_exp_f32 v37, v197
    v_add_f32 v17, v17, v41
    v_exp_f32 v38, v198
    v_cvt_pk_bf16_f32 v226, v36, v37
    v_add_f32 v17, v17, v36
    v_exp_f32 v39, v199
    v_add_f32 v17, v17, v37
    v_exp_f32 v40, v200
    v_cvt_pk_bf16_f32 v227, v38, v39
    v_add_f32 v17, v17, v38
    v_exp_f32 v41, v201
    v_add_f32 v17, v17, v39
    v_exp_f32 v36, v202
    v_cvt_pk_bf16_f32 v228, v40, v41
    v_add_f32 v18, v40, v41
    v_exp_f32 v37, v203
    v_exp_f32 v38, v204
    v_cvt_pk_bf16_f32 v229, v36, v37
    v_add_f32 v18, v18, v36
    v_exp_f32 v39, v205
    v_add_f32 v18, v18, v37
    v_exp_f32 v40, v206
    v_cvt_pk_bf16_f32 v230, v38, v39
    v_add_f32 v18, v18, v38
    v_exp_f32 v41, v207
    v_add_f32 v18, v18, v39
    v_add_f32 v18, v18, v40
    v_add_f32 v18, v18, v41
    v_cvt_pk_bf16_f32 v231, v40, v41
    s_nop 1
    s_branch L_ret15
L_rare16:
    s_nop 7
    v_max3_f32 v48, v160, v161, v162
    v_max3_f32 v49, v163, v164, v165
    v_max3_f32 v48, v48, v166, v167
    v_max_f32 v48, v48, v49
    v_mov_b32 v49, v48
    s_nop 1
    v_permlane16_swap_b32 v48, v49
    s_nop 1
    v_max_f32 v48, v48, v49
    v_mov_b32 v49, v48
    s_nop 1
    v_permlane32_swap_b32 v48, v49
    s_nop 1
    v_max_f32 v48, v48, v49
    v_max_f32 v42, 0, v48
    v_exp_f32 v45, -v42
    v_sub_f32 v10, v10, v42
    v_mov_b32 v52, v10
    v_mov_b32 v53, v10
    v_mov_b32 v54, v10
    v_mov_b32 v55, v10
    v_sub_f32 v160, v160, v42
    v_sub_f32 v161, v161, v42
    v_sub_f32 v162, v162, v42
    v_sub_f32 v163, v163, v42
    v_sub_f32 v164, v164, v42
    v_sub_f32 v165, v165, v42
    v_sub_f32 v166, v166, v42
    v_sub_f32 v167, v167, v42
    v_sub_f32 v184, v184, v42
    v_sub_f32 v185, v185, v42
    v_sub_f32 v186, v186, v42
    v_sub_f32 v187, v187, v42
    v_sub_f32 v188, v188, v42
    v_sub_f32 v189, v189, v42
    v_sub_f32 v190, v190, v42
    v_sub_f32 v191, v191, v42
    v_mul_f32 v13, v45, v13
    v_mul_f32 v64, v45, v64
    v_mul_f32 v65, v45, v65
    v_mul_f32 v66, v45, v66
    v_mul_f32 v67, v45, v67
    v_mul_f32 v76, v45, v76
    v_mul_f32 v77, v45, v77
    v_mul_f32 v78, v45, v78
    v_mul_f32 v79, v45, v79
    v_mul_f32 v88, v45, v88
    v_mul_f32 v89, v45, v89
    v_mul_f32 v90, v45, v90
    v_mul_f32 v91, v45, v91
    v_mul_f32 v100, v45, v100
    v_mul_f32 v101, v45, v101
    v_mul_f32 v102, v45, v102
    v_mul_f32 v103, v45, v103
    v_mul_f32 v112, v45, v112
    v_mul_f32 v113, v45, v113
    v_mul_f32 v114, v45, v114
    v_mul_f32 v115, v45, v115
    v_mul_f32 v124, v45, v124
    v_mul_f32 v125, v45, v125
    v_mul_f32 v126, v45, v126
    v_mul_f32 v127, v45, v127
    v_mul_f32 v136, v45, v136
    v_mul_f32 v137, v45, v137
    v_mul_f32 v138, v45, v138
    v_mul_f32 v139, v45, v139
    v_mul_f32 v148, v45, v148
    v_mul_f32 v149, v45, v149
    v_mul_f32 v150, v45, v150
    v_mul_f32 v151, v45, v151
    v_max3_f32 v48, v168, v169, v170
    v_max3_f32 v49, v171, v172, v173
    v_max3_f32 v48, v48, v174, v175
    v_max_f32 v48, v48, v49
    v_mov_b32 v49, v48
    s_nop 1
    v_permlane16_swap_b32 v48, v49
    s_nop 1
    v_max_f32 v48, v48, v49
    v_mov_b32 v49, v48
    s_nop 1
    v_permlane32_swap_b32 v48, v49
    s_nop 1
    v_max_f32 v48, v48, v49
    v_max_f32 v43, 0, v48
    v_exp_f32 v46, -v43
    v_sub_f32 v11, v11, v43
    v_mov_b32 v56, v11
    v_mov_b32 v57, v11
    v_mov_b32 v58, v11
    v_mov_b32 v59, v11
    v_sub_f32 v168, v168, v43
    v_sub_f32 v169, v169, v43
    v_sub_f32 v170, v170, v43
    v_sub_f32 v171, v171, v43
    v_sub_f32 v172, v172, v43
    v_sub_f32 v173, v173, v43
    v_sub_f32 v174, v174, v43
    v_sub_f32 v175, v175, v43
    v_sub_f32 v192, v192, v43
    v_sub_f32 v193, v193, v43
    v_sub_f32 v194, v194, v43
    v_sub_f32 v195, v195, v43
    v_sub_f32 v196, v196, v43
    v_sub_f32 v197, v197, v43
    v_sub_f32 v198, v198, v43
    v_sub_f32 v199, v199, v43
    v_mul_f32 v14, v46, v14
    v_mul_f32 v68, v46, v68
    v_mul_f32 v69, v46, v69
    v_mul_f32 v70, v46, v70
    v_mul_f32 v71, v46, v71
    v_mul_f32 v80, v46, v80
    v_mul_f32 v81, v46, v81
    v_mul_f32 v82, v46, v82
    v_mul_f32 v83, v46, v83
    v_mul_f32 v92, v46, v92
    v_mul_f32 v93, v46, v93
    v_mul_f32 v94, v46, v94
    v_mul_f32 v95, v46, v95
    v_mul_f32 v104, v46, v104
    v_mul_f32 v105, v46, v105
    v_mul_f32 v106, v46, v106
    v_mul_f32 v107, v46, v107
    v_mul_f32 v116, v46, v116
    v_mul_f32 v117, v46, v117
    v_mul_f32 v118, v46, v118
    v_mul_f32 v119, v46, v119
    v_mul_f32 v128, v46, v128
    v_mul_f32 v129, v46, v129
    v_mul_f32 v130, v46, v130
    v_mul_f32 v131, v46, v131
    v_mul_f32 v140, v46, v140
    v_mul_f32 v141, v46, v141
    v_mul_f32 v142, v46, v142
    v_mul_f32 v143, v46, v143
    v_mul_f32 v152, v46, v152
    v_mul_f32 v153, v46, v153
    v_mul_f32 v154, v46, v154
    v_mul_f32 v155, v46, v155
    v_max3_f32 v48, v176, v177, v178
    v_max3_f32 v49, v179, v180, v181
    v_max3_f32 v48, v48, v182, v183
    v_max_f32 v48, v48, v49
    v_mov_b32 v49, v48
    s_nop 1
    v_permlane16_swap_b32 v48, v49
    s_nop 1
    v_max_f32 v48, v48, v49
    v_mov_b32 v49, v48
    s_nop 1
    v_permlane32_swap_b32 v48, v49
    s_nop 1
    v_max_f32 v48, v48, v49
    v_max_f32 v44, 0, v48
    v_exp_f32 v47, -v44
    v_sub_f32 v12, v12, v44
    v_mov_b32 v60, v12
    v_mov_b32 v61, v12
    v_mov_b32 v62, v12
    v_mov_b32 v63, v12
    v_sub_f32 v176, v176, v44
    v_sub_f32 v177, v177, v44
    v_sub_f32 v178, v178, v44
    v_sub_f32 v179, v179, v44
    v_sub_f32 v180, v180, v44
    v_sub_f32 v181, v181, v44
    v_sub_f32 v182, v182, v44
    v_sub_f32 v183, v183, v44
    v_sub_f32 v200, v200, v44
    v_sub_f32 v201, v201, v44
    v_sub_f32 v202, v202, v44
    v_sub_f32 v203, v203, v44
    v_sub_f32 v204, v204, v44
    v_sub_f32 v205, v205, v44
    v_sub_f32 v206, v206, v44
    v_sub_f32 v207, v207, v44
    v_mul_f32 v15, v47, v15
    v_mul_f32 v72, v47, v72
    v_mul_f32 v73, v47, v73
    v_mul_f32 v74, v47, v74
    v_mul_f32 v75, v47, v75
    v_mul_f32 v84, v47, v84
    v_mul_f32 v85, v47, v85
    v_mul_f32 v86, v47, v86
    v_mul_f32 v87, v47, v87
    v_mul_f32 v96, v47, v96
    v_mul_f32 v97, v47, v97
    v_mul_f32 v98, v47, v98
    v_mul_f32 v99, v47, v99
    v_mul_f32 v108, v47, v108
    v_mul_f32 v109, v47, v109
    v_mul_f32 v110, v47, v110
    v_mul_f32 v111, v47, v111
    v_mul_f32 v120, v47, v120
    v_mul_f32 v121, v47, v121
    v_mul_f32 v122, v47, v122
    v_mul_f32 v123, v47, v123
    v_mul_f32 v132, v47, v132
    v_mul_f32 v133, v47, v133
    v_mul_f32 v134, v47, v134
    v_mul_f32 v135, v47, v135
    v_mul_f32 v144, v47, v144
    v_mul_f32 v145, v47, v145
    v_mul_f32 v146, v47, v146
    v_mul_f32 v147, v47, v147
    v_mul_f32 v156, v47, v156
    v_mul_f32 v157, v47, v157
    v_mul_f32 v158, v47, v158
    v_mul_f32 v159, v47, v159
    v_exp_f32 v36, v160
    v_exp_f32 v37, v161
    v_exp_f32 v38, v162
    v_cvt_pk_bf16_f32 v208, v36, v37
    v_add_f32 v16, v36, v37
    v_exp_f32 v39, v163
    v_exp_f32 v40, v164
    v_cvt_pk_bf16_f32 v209, v38, v39
    v_add_f32 v16, v16, v38
    v_exp_f32 v41, v165
    v_add_f32 v16, v16, v39
    v_exp_f32 v36, v166
    v_cvt_pk_bf16_f32 v210, v40, v41
    v_add_f32 v16, v16, v40
    v_exp_f32 v37, v167
    v_add_f32 v16, v16, v41
    v_exp_f32 v38, v168
    v_cvt_pk_bf16_f32 v211, v36, v37
    v_add_f32 v16, v16, v36
    v_exp_f32 v39, v169
    v_add_f32 v16, v16, v37
    v_exp_f32 v40, v170
    v_cvt_pk_bf16_f32 v212, v38, v39
    v_add_f32 v17, v38, v39
    v_exp_f32 v41, v171
    v_exp_f32 v36, v172
    v_cvt_pk_bf16_f32 v213, v40, v41
    v_add_f32 v17, v17, v40
    v_exp_f32 v37, v173
    v_add_f32 v17, v17, v41
    v_exp_f32 v38, v174
    v_cvt_pk_bf16_f32 v214, v36, v37
    v_add_f32 v17, v17, v36
    v_exp_f32 v39, v175
    v_add_f32 v17, v17, v37
    v_exp_f32 v40, v176
    v_cvt_pk_bf16_f32 v215, v38, v39
    v_add_f32 v17, v17, v38
    v_exp_f32 v41, v177
    v_add_f32 v17, v17, v39
    v_exp_f32 v36, v178
    v_cvt_pk_bf16_f32 v216, v40, v41
    v_add_f32 v18, v40, v41
    v_exp_f32 v37, v179
    v_exp_f32 v38, v180
    v_cvt_pk_bf16_f32 v217, v36, v37
    v_add_f32 v18, v18, v36
    v_exp_f32 v39, v181
    v_add_f32 v18, v18, v37
    v_exp_f32 v40, v182
    v_cvt_pk_bf16_f32 v218, v38, v39
    v_add_f32 v18, v18, v38
    v_exp_f32 v41, v183
    v_add_f32 v18, v18, v39
    v_add_f32 v18, v18, v40
    v_add_f32 v18, v18, v41
    v_cvt_pk_bf16_f32 v219, v40, v41
    s_nop 1
    s_branch L_ret16
L_rare17:
    s_nop 7
    v_max3_f32 v48, v184, v185, v186
    v_max3_f32 v49, v187, v188, v189
    v_max3_f32 v48, v48, v190, v191
    v_max_f32 v48, v48, v49
    v_mov_b32 v49, v48
    s_nop 1
    v_permlane16_swap_b32 v48, v49
    s_nop 1
    v_max_f32 v48, v48, v49
    v_mov_b32 v49, v48
    s_nop 1
    v_permlane32_swap_b32 v48, v49
    s_nop 1
    v_max_f32 v48, v48, v49
    v_max_f32 v42, 0, v48
    v_exp_f32 v45, -v42
    v_sub_f32 v10, v10, v42
    v_mov_b32 v52, v10
    v_mov_b32 v53, v10
    v_mov_b32 v54, v10
    v_mov_b32 v55, v10
    v_sub_f32 v184, v184, v42
    v_sub_f32 v185, v185, v42
    v_sub_f32 v186, v186, v42
    v_sub_f32 v187, v187, v42
    v_sub_f32 v188, v188, v42
    v_sub_f32 v189, v189, v42
    v_sub_f32 v190, v190, v42
    v_sub_f32 v191, v191, v42
    v_mul_f32 v13, v45, v13
    v_mul_f32 v64, v45, v64
    v_mul_f32 v65, v45, v65
    v_mul_f32 v66, v45, v66
    v_mul_f32 v67, v45, v67
    v_mul_f32 v76, v45, v76
    v_mul_f32 v77, v45, v77
    v_mul_f32 v78, v45, v78
    v_mul_f32 v79, v45, v79
    v_mul_f32 v88, v45, v88
    v_mul_f32 v89, v45, v89
    v_mul_f32 v90, v45, v90
    v_mul_f32 v91, v45, v91
    v_mul_f32 v100, v45, v100
    v_mul_f32 v101, v45, v101
    v_mul_f32 v102, v45, v102
    v_mul_f32 v103, v45, v103
    v_mul_f32 v112, v45, v112
    v_mul_f32 v113, v45, v113
    v_mul_f32 v114, v45, v114
    v_mul_f32 v115, v45, v115
    v_mul_f32 v124, v45, v124
    v_mul_f32 v125, v45, v125
    v_mul_f32 v126, v45, v126
    v_mul_f32 v127, v45, v127
    v_mul_f32 v136, v45, v136
    v_mul_f32 v137, v45, v137
    v_mul_f32 v138, v45, v138
    v_mul_f32 v139, v45, v139
    v_mul_f32 v148, v45, v148
    v_mul_f32 v149, v45, v149
    v_mul_f32 v150, v45, v150
    v_mul_f32 v151, v45, v151
    v_exp_f32 v36, v184
    v_exp_f32 v37, v185
    v_exp_f32 v38, v186
    v_cvt_pk_bf16_f32 v220, v36, v37
    v_add_f32 v16, v36, v37
    v_exp_f32 v39, v187
    v_exp_f32 v40, v188
    v_cvt_pk_bf16_f32 v221, v38, v39
    v_add_f32 v16, v16, v38
    v_exp_f32 v41, v189
    v_add_f32 v16, v16, v39
    v_exp_f32 v36, v190
    v_cvt_pk_bf16_f32 v222, v40, v41
    v_add_f32 v16, v16, v40
    v_exp_f32 v37, v191
    v_add_f32 v16, v16, v41
    v_add_f32 v16, v16, v36
    v_add_f32 v16, v16, v37
    v_cvt_pk_bf16_f32 v223, v36, v37
    s_nop 1
    s_branch L_ret17
L_rare18:
    s_nop 7
    v_max3_f32 v48, v192, v193, v194
    v_max3_f32 v49, v195, v196, v197
    v_max3_f32 v48, v48, v198, v199
    v_max_f32 v48, v48, v49
    v_mov_b32 v49, v48
    s_nop 1
    v_permlane16_swap_b32 v48, v49
    s_nop 1
    v_max_f32 v48, v48, v49
    v_mov_b32 v49, v48
    s_nop 1
    v_permlane32_swap_b32 v48, v49
    s_nop 1
    v_max_f32 v48, v48, v49
    v_max_f32 v43, 0, v48
    v_exp_f32 v46, -v43
    v_sub_f32 v11, v11, v43
    v_mov_b32 v56, v11
    v_mov_b32 v57, v11
    v_mov_b32 v58, v11
    v_mov_b32 v59, v11
    v_sub_f32 v192, v192, v43
    v_sub_f32 v193, v193, v43
    v_sub_f32 v194, v194, v43
    v_sub_f32 v195, v195, v43
    v_sub_f32 v196, v196, v43
    v_sub_f32 v197, v197, v43
    v_sub_f32 v198, v198, v43
    v_sub_f32 v199, v199, v43
    v_mul_f32 v14, v46, v14
    v_mul_f32 v68, v46, v68
    v_mul_f32 v69, v46, v69
    v_mul_f32 v70, v46, v70
    v_mul_f32 v71, v46, v71
    v_mul_f32 v80, v46, v80
    v_mul_f32 v81, v46, v81
    v_mul_f32 v82, v46, v82
    v_mul_f32 v83, v46, v83
    v_mul_f32 v92, v46, v92
    v_mul_f32 v93, v46, v93
    v_mul_f32 v94, v46, v94
    v_mul_f32 v95, v46, v95
    v_mul_f32 v104, v46, v104
    v_mul_f32 v105, v46, v105
    v_mul_f32 v106, v46, v106
    v_mul_f32 v107, v46, v107
    v_mul_f32 v116, v46, v116
    v_mul_f32 v117, v46, v117
    v_mul_f32 v118, v46, v118
    v_mul_f32 v119, v46, v119
    v_mul_f32 v128, v46, v128
    v_mul_f32 v129, v46, v129
    v_mul_f32 v130, v46, v130
    v_mul_f32 v131, v46, v131
    v_mul_f32 v140, v46, v140
    v_mul_f32 v141, v46, v141
    v_mul_f32 v142, v46, v142
    v_mul_f32 v143, v46, v143
    v_mul_f32 v152, v46, v152
    v_mul_f32 v153, v46, v153
    v_mul_f32 v154, v46, v154
    v_mul_f32 v155, v46, v155
    v_exp_f32 v36, v192
    v_exp_f32 v37, v193
    v_exp_f32 v38, v194
    v_cvt_pk_bf16_f32 v224, v36, v37
    v_add_f32 v17, v36, v37
    v_exp_f32 v39, v195
    v_exp_f32 v40, v196
    v_cvt_pk_bf16_f32 v225, v38, v39
    v_add_f32 v17, v17, v38
    v_exp_f32 v41, v197
    v_add_f32 v17, v17, v39
    v_exp_f32 v36, v198
    v_cvt_pk_bf16_f32 v226, v40, v41
    v_add_f32 v17, v17, v40
    v_exp_f32 v37, v199
    v_add_f32 v17, v17, v41
    v_add_f32 v17, v17, v36
    v_add_f32 v17, v17, v37
    v_cvt_pk_bf16_f32 v227, v36, v37
    s_nop 1
    s_branch L_ret18
L_rare19:
    s_nop 7
    v_max3_f32 v48, v200, v201, v202
    v_max3_f32 v49, v203, v204, v205
    v_max3_f32 v48, v48, v206, v207
    v_max_f32 v48, v48, v49
    v_mov_b32 v49, v48
    s_nop 1
    v_permlane16_swap_b32 v48, v49
    s_nop 1
    v_max_f32 v48, v48, v49
    v_mov_b32 v49, v48
    s_nop 1
    v_permlane32_swap_b32 v48, v49
    s_nop 1
    v_max_f32 v48, v48, v49
    v_max_f32 v44, 0, v48
    v_exp_f32 v47, -v44
    v_sub_f32 v12, v12, v44
    v_mov_b32 v60, v12
    v_mov_b32 v61, v12
    v_mov_b32 v62, v12
    v_mov_b32 v63, v12
    v_sub_f32 v200, v200, v44
    v_sub_f32 v201, v201, v44
    v_sub_f32 v202, v202, v44
    v_sub_f32 v203, v203, v44
    v_sub_f32 v204, v204, v44
    v_sub_f32 v205, v205, v44
    v_sub_f32 v206, v206, v44
    v_sub_f32 v207, v207, v44
    v_mul_f32 v15, v47, v15
    v_mul_f32 v72, v47, v72
    v_mul_f32 v73, v47, v73
    v_mul_f32 v74, v47, v74
    v_mul_f32 v75, v47, v75
    v_mul_f32 v84, v47, v84
    v_mul_f32 v85, v47, v85
    v_mul_f32 v86, v47, v86
    v_mul_f32 v87, v47, v87
    v_mul_f32 v96, v47, v96
    v_mul_f32 v97, v47, v97
    v_mul_f32 v98, v47, v98
    v_mul_f32 v99, v47, v99
    v_mul_f32 v108, v47, v108
    v_mul_f32 v109, v47, v109
    v_mul_f32 v110, v47, v110
    v_mul_f32 v111, v47, v111
    v_mul_f32 v120, v47, v120
    v_mul_f32 v121, v47, v121
    v_mul_f32 v122, v47, v122
    v_mul_f32 v123, v47, v123
    v_mul_f32 v132, v47, v132
    v_mul_f32 v133, v47, v133
    v_mul_f32 v134, v47, v134
    v_mul_f32 v135, v47, v135
    v_mul_f32 v144, v47, v144
    v_mul_f32 v145, v47, v145
    v_mul_f32 v146, v47, v146
    v_mul_f32 v147, v47, v147
    v_mul_f32 v156, v47, v156
    v_mul_f32 v157, v47, v157
    v_mul_f32 v158, v47, v158
    v_mul_f32 v159, v47, v159
    v_exp_f32 v36, v200
    v_exp_f32 v37, v201
    v_exp_f32 v38, v202
    v_cvt_pk_bf16_f32 v228, v36, v37
    v_add_f32 v18, v36, v37
    v_exp_f32 v39, v203
    v_exp_f32 v40, v204
    v_cvt_pk_bf16_f32 v229, v38, v39
    v_add_f32 v18, v18, v38
    v_exp_f32 v41, v205
    v_add_f32 v18, v18, v39
    v_exp_f32 v36, v206
    v_cvt_pk_bf16_f32 v230, v40, v41
    v_add_f32 v18, v18, v40
    v_exp_f32 v37, v207
    v_add_f32 v18, v18, v41
    v_add_f32 v18, v18, v36
    v_add_f32 v18, v18, v37
    v_cvt_pk_bf16_f32 v231, v36, v37
    s_nop 1
    s_branch L_ret19
.section .rodata,"a"
.p2align 6
.amdhsa_kernel standalone__gqa_softmax__near_ridge_kernel
  .amdhsa_next_free_vgpr 400
  .amdhsa_next_free_sgpr 80
  .amdhsa_accum_offset 256
  .amdhsa_group_segment_fixed_size 0
  .amdhsa_kernarg_size 48
  .amdhsa_user_sgpr_count 2
  .amdhsa_user_sgpr_kernarg_segment_ptr 1
  .amdhsa_system_sgpr_workgroup_id_x 1
.end_amdhsa_kernel
```
